```python
import torch

def _softmax(x, axis=-1):
    return torch.softmax(x, dim=axis)
def _gelu(x):
    return torch.nn.functional.gelu(x, approximate="tanh")
def _silu(x):
    return torch.nn.functional.silu(x)
def _sigmoid(x):
    return torch.sigmoid(x)
def _layernorm(x, axis=-1, eps=1e-5):
    m = x.mean(dim=axis, keepdim=True)
    v = x.var(dim=axis, keepdim=True, unbiased=False)
    return (x - m) / torch.sqrt(v + eps)
def _scatter_add(tgt, idx, src, axis=0):
    return tgt.clone().index_add_(axis, idx, src)
def _segment_sum(src, seg, n):
    out = torch.zeros((n,) + src.shape[1:], dtype=src.dtype)
    return out.index_add_(0, seg, src)
def _pad(x, pw):
    flat = tuple(v for pair in reversed(pw) for v in pair)
    return torch.nn.functional.pad(x, flat)

kernel_name = 'recurrent_scan__ssm_conv_s5__dense_activation_mish__prompt'

def setup_inputs():

    _w = (lambda a: (lambda t: t.to(torch.bfloat16) if t.is_floating_point() else t)(torch.as_tensor(a)))
    def _A_setup():
        B, S, D = 1, 2048, 512
        P = D
        Lambda_re = -0.5 * (lambda _x: torch.exp(torch.as_tensor(_x)))((lambda *s: torch.randn(*s, dtype=torch.bfloat16) * 0.4)(P))
        Lambda_im = (lambda *s: torch.randn(*s, dtype=torch.bfloat16) * 0.8)(P) * 1.0
        B_re = (lambda *s: torch.randn(*s, dtype=torch.bfloat16) * 0.4)(P, D) * (D ** -0.5)
        B_im = (lambda *s: torch.randn(*s, dtype=torch.bfloat16) * 0.4)(P, D) * (D ** -0.5)
        C_re = (lambda *s: torch.randn(*s, dtype=torch.bfloat16) * 0.4)(D, P) * (P ** -0.5)
        C_im = (lambda *s: torch.randn(*s, dtype=torch.bfloat16) * 0.4)(D, P) * (P ** -0.5)
        log_dt = (lambda *s: torch.randn(*s, dtype=torch.bfloat16) * 0.4)(P) * 0.3 - 2.0
        Dskip = (lambda *s: torch.randn(*s, dtype=torch.bfloat16) * 0.2)(D)
        return {
            "x": _w((lambda *s: torch.randn(*s, dtype=torch.bfloat16) * 0.05)(B, S, D)),
            "Lambda_re": _w(Lambda_re),
            "Lambda_im": _w(Lambda_im),
            "B_re": _w(B_re),
            "B_im": _w(B_im),
            "C_re": _w(C_re),
            "C_im": _w(C_im),
            "log_dt": _w(log_dt),
            "Dskip": _w(Dskip),
        }
    _A_in = _A_setup()

    def _B_setup():
        B, S, D, F = 1, 2048, 512, 1376
        return {
            "x": _w((lambda *s: torch.randn(*s, dtype=torch.bfloat16) * 0.05)(B, S, D)),
            "w1": _w((lambda *s: torch.randn(*s, dtype=torch.bfloat16) * 0.8)(D, F) * (D ** -0.5)),
            "b1": _w((lambda *s: torch.randn(*s, dtype=torch.bfloat16) * 0.2)(F)),
            "w2": _w((lambda *s: torch.randn(*s, dtype=torch.bfloat16) * 0.1)(F, D) * (F ** -0.5)),
        }
    _B_in = _B_setup()

    return {
        "A_x": _A_in["x"],
        "A_Lambda_re": _A_in["Lambda_re"],
        "A_Lambda_im": _A_in["Lambda_im"],
        "A_B_re": _A_in["B_re"],
        "A_B_im": _A_in["B_im"],
        "A_C_re": _A_in["C_re"],
        "A_C_im": _A_in["C_im"],
        "A_log_dt": _A_in["log_dt"],
        "A_Dskip": _A_in["Dskip"],
        "B_x": _B_in["x"],
        "B_w1": _B_in["w1"],
        "B_b1": _B_in["b1"],
        "B_w2": _B_in["w2"],
    }

def reference(A_x, A_Lambda_re, A_Lambda_im, A_B_re, A_B_im, A_C_re, A_C_im, A_log_dt, A_Dskip, B_x, B_w1, B_b1, B_w2):
    def _A_ref(x, Lambda_re, Lambda_im, B_re, B_im, C_re, C_im, log_dt, Dskip):
        Bsz, L, H = x.shape
        Lam = Lambda_re + 1j * Lambda_im
        Bmat = B_re + 1j * B_im
        Cmat = C_re + 1j * C_im
        dt = torch.exp(log_dt)
        Lam_bar = torch.exp(dt * Lam)
        B_bar = ((Lam_bar - 1.0) / Lam)[:, None] * Bmat
        Bu = torch.einsum("bld,pd->blp", x + 0j, B_bar)
        h = torch.zeros_like(Bu[:, 0, :])
        hs = []
        for t in range(L):
            h = Lam_bar[None, :] * h + Bu[:, t, :]
            hs.append(h)
        hseq = torch.stack(hs, 1)
        y = 2.0 * torch.einsum("blp,dp->bld", hseq, Cmat).real + x * Dskip[None, None, :]
        return y

    def _B_ref(x, w1, b1, w2):
        h = torch.einsum("bsd,df->bsf", x, w1) + b1
        sp = torch.log1p(torch.exp(-torch.abs(h))) + torch.where(h > 0, h, torch.zeros_like(h))
        act = h * torch.tanh(sp)
        return torch.einsum("bsf,fd->bsd", act, w2)

    x = A_x
    xn = _layernorm(x, axis=-1)
    s = _A_ref(xn, A_Lambda_re, A_Lambda_im, A_B_re, A_B_im, A_C_re, A_C_im, A_log_dt, A_Dskip)
    g = _silu(_B_ref(xn, B_w1, B_b1, B_w2))
    return x + s * g
```

```asm
; @launch grid=(256,1,1) block=(512,1,1) lds=163840
.amdgcn_target "amdgcn-amd-amdhsa--gfx950"
.text
.globl recurrent_scan__ssm_conv_s5__dense_activation_mish__prompt_kernel
.p2align 8
.type recurrent_scan__ssm_conv_s5__dense_activation_mish__prompt_kernel,@function
recurrent_scan__ssm_conv_s5__dense_activation_mish__prompt_kernel:
    s_cmp_ge_u32 s2, 256
    s_cbranch_scc1 L_end
    s_load_dwordx16 s[16:31], s[0:1], 0
    s_load_dwordx16 s[32:47], s[0:1], 64
    s_getpc_b64 s[96:97]
L_pc:
    v_lshlrev_b32 v14, 6, v0
    v_min_u32 v14, L_end-L_pc, v14
    global_load_dword v248, v14, s[96:97]
    v_lshrrev_b32 v1, 6, v0
    v_and_b32 v0, 63, v0
    v_readfirstlane_b32 s3, v1
    s_and_b32 s14, s2, 7
    s_lshr_b32 s15, s2, 3
    s_lshr_b32 s4, s14, 1
    s_lshl_b32 s4, s4, 2
    s_lshr_b32 s5, s15, 3
    s_add_u32 s4, s4, s5
    s_and_b32 s5, s14, 1
    s_lshl_b32 s5, s5, 3
    s_and_b32 s6, s15, 7
    s_add_u32 s5, s5, s6
    s_bfe_u32 s12, s4, 0x10002
    s_lshl1_add_u32 s12, s4, s12
    s_add_u32 s12, s12, s5
    s_and_b32 s12, s12, 7
    s_mul_i32 s6, s5, 43
    s_add_u32 s7, s6, 43
    s_lshr_b32 s6, s6, 4
    s_lshr_b32 s7, s7, 4
    s_sub_u32 s7, s7, s6
    s_and_b32 s10, s5, 1
    s_lshl_b32 s11, s4, 1
    s_add_u32 s10, s10, s11
    s_lshr_b32 s11, s5, 1
    s_and_b32 s9, s3, 3
    s_mov_b32 s100, 0x3f803f80
    v_and_b32 v1, 31, v0
    v_lshrrev_b32 v2, 5, v0
    s_cmp_lt_u32 s3, 4
    s_cbranch_scc1 L_compute
    s_lshl_b32 s14, s4, 4
    s_add_u32 s14, s14, s5
    s_lshl2_add_u32 s14, s14, s9
    s_lshl_b32 s14, s14, 1
    v_add_lshl_u32 v72, v2, s14, 3
    v_lshlrev_b32 v73, 7, v72
    v_lshl_add_u32 v73, v1, 4, v73
    v_lshrrev_b32 v13, 3, v0
    v_and_b32 v14, 3, v13
    v_lshrrev_b32 v15, 4, v0
    v_and_b32 v45, 7, v0
    v_xor_b32 v45, v45, v15
    v_lshlrev_b32 v45, 4, v45
    v_xor_b32 v46, 64, v45
    s_lshl_b32 s14, s4, 7
    s_lshl_b32 s15, s9, 5
    s_add_u32 s14, s14, s15
    v_lshl_add_u32 v47, v2, 4, v14
    v_add_lshl_u32 v47, v47, s14, 10
    v_add_u32 v16, v47, v45
    v_add_u32 v17, v47, v46
    v_add_u32 v17, 3072, v17
    v_add_u32 v18, v47, v45
    v_add_u32 v18, 6144, v18
    v_add_u32 v19, v47, v46
    v_add_u32 v19, 9216, v19
    s_lshl_b32 s14, s5, 5
    s_and_b32 s15, s9, 1
    s_lshl_b32 s15, s15, 4
    s_add_u32 s14, s14, s15
    v_lshl_add_u32 v47, v2, 3, v14
    v_add_lshl_u32 v47, v47, s14, 10
    v_add_u32 v20, v47, v45
    v_add_u32 v21, v47, v46
    v_add_u32 v21, 3072, v21
    s_mul_i32 s14, s9, 44032
    s_lshl_b32 s15, s6, 6
    s_add_u32 s14, s14, s15
    v_add_u32 v47, 0, v0
    v_mul_u32_u24 v48, 171, v47
    v_lshrrev_b32 v48, 11, v48
    v_mul_u32_u24 v48, 2560, v48
    v_lshl_add_u32 v48, v0, 4, v48
    v_add_u32 v22, s14, v48
    v_add_u32 v47, 64, v0
    v_mul_u32_u24 v48, 171, v47
    v_lshrrev_b32 v48, 11, v48
    v_mul_u32_u24 v48, 2560, v48
    v_lshl_add_u32 v48, v0, 4, v48
    v_add_u32 v23, s14, v48
    v_add_u32 v47, 128, v0
    v_mul_u32_u24 v48, 171, v47
    v_lshrrev_b32 v48, 11, v48
    v_mul_u32_u24 v48, 2560, v48
    v_lshl_add_u32 v48, v0, 4, v48
    v_add_u32 v24, s14, v48
    s_lshl_b32 s96, s9, 12
    s_lshl_b32 s97, s9, 11
    s_add_u32 s97, s97, 16384
    s_mul_i32 s98, s9, 3072
    s_add_u32 s98, s98, 24576
    s_mov_b32 s92, 0
    s_mov_b32 s93, s12
    s_waitcnt lgkmcnt(0)
    s_load_dword s8, s[46:47], 0
    s_mov_b32 s48, s16
    s_mov_b32 s49, s17
    s_mov_b32 s50, 0x200000
    s_mov_b32 s51, 0x20000
    s_cmp_lt_u32 s9, 2
    s_cselect_b32 s52, s22, s24
    s_cselect_b32 s53, s23, s25
    s_mov_b32 s54, 0x80000
    s_mov_b32 s55, 0x20000
    s_mov_b32 s56, s36
    s_mov_b32 s57, s37
    s_mov_b32 s58, 0x158000
    s_mov_b32 s59, 0x20000
    buffer_load_dwordx4 v[64:67], v73, s[48:51], 0 offen
    buffer_load_dwordx4 v[68:71], v73, s[48:51], 0 offen offset:512
    s_lshl_b32 s94, s93, 7
    s_mul_i32 s95, s93, 176128
    s_add_u32 m0, s92, s96
s_nop 0
    buffer_load_dwordx4 v16, s[48:51], s94 offen offset:0 lds
    buffer_load_dwordx4 v17, s[48:51], s94 offen offset:1024 lds
    buffer_load_dwordx4 v18, s[48:51], s94 offen offset:2048 lds
    buffer_load_dwordx4 v19, s[48:51], s94 offen offset:3072 lds
    s_add_u32 m0, s92, s97
s_nop 0
    buffer_load_dwordx4 v20, s[52:55], s94 offen offset:0 lds
    buffer_load_dwordx4 v21, s[52:55], s94 offen offset:1024 lds
    s_add_u32 m0, s92, s98
s_nop 0
    buffer_load_dwordx4 v22, s[56:59], s95 offen offset:0 lds
    buffer_load_dwordx4 v23, s[56:59], s95 offen offset:1024 lds
    buffer_load_dwordx4 v24, s[56:59], s95 offen offset:2048 lds
    s_add_u32 s93, s93, 1
    s_and_b32 s93, s93, 7
    s_add_u32 s92, s92, 36864
    s_cmp_eq_u32 s92, 110592
    s_cselect_b32 s92, 0, s92
    s_lshl_b32 s14, s6, 5
    v_add_lshl_u32 v47, v0, s14, 1
    v_add_lshl_u32 v48, v1, s14, 1
    global_load_ushort v37, v47, s[38:39]
    v_min_u32 v48, 2622, v48
    global_load_ushort v39, v48, s[38:39] offset:128
    s_mov_b64 s[0:1], s[32:33]
    s_lshl1_add_u32 s17, s11, s10
    s_and_b32 s17, s17, 7
    s_mul_i32 s44, s17, 11
    s_lshr_b32 s44, s44, 3
    s_lshl_b32 s44, s44, 15
    s_cmp_eq_u32 s9, 3
    s_cselect_b32 s45, 10, 11
    s_lshl_b32 s45, s45, 15
    s_and_b32 s16, s17, 4
    s_bfe_u32 s14, s17, 0x10001
    s_or_b32 s16, s16, s14
    s_and_b32 s14, s17, 1
    s_lshl1_add_u32 s16, s14, s16
    s_lshl_b32 s16, s16, 11
    s_mov_b32 s60, s40
    s_mov_b32 s61, s41
    s_mov_b32 s62, 0x158000
    s_mov_b32 s63, 0x20000
    s_mov_b32 s64, s26
    s_mov_b32 s65, s27
    s_mov_b32 s66, 0x80000
    s_mov_b32 s67, 0x20000
    s_mov_b32 s68, s28
    s_mov_b32 s69, s29
    s_mov_b32 s70, 0x80000
    s_mov_b32 s71, 0x20000
    s_bitcmp1_b32 s17, 1
    s_cselect_b64 s[64:65], s[28:29], s[26:27]
    s_cselect_b64 s[68:69], s[26:27], s[28:29]
    s_add_u32 s72, s46, 0x100000
    s_addc_u32 s73, s47, 0
    s_mov_b32 s74, 0x980000
    s_mov_b32 s75, 0x20000
    s_mov_b32 s76, s42
    s_mov_b32 s77, s43
    s_mov_b32 s78, 0x400000
    s_mov_b32 s79, 0x20000
    s_lshl_b32 s14, s5, 13
    s_add_u32 s14, s14, 0x1000
    s_add_u32 s80, s46, s14
    s_addc_u32 s81, s47, 0
    s_mov_b32 s82, 0x2000
    s_mov_b32 s83, 0x20000
    s_add_u32 s84, s46, 0x40000
    s_addc_u32 s85, s47, 0
    s_mov_b32 s86, 0xb0000
    s_mov_b32 s87, 0x20000
    v_bfe_u32 v47, v0, 4, 1
    v_lshlrev_b32 v47, 2, v47
    v_and_b32 v48, 7, v0
    v_xor_b32 v47, v47, v48
    v_lshlrev_b32 v47, 4, v47
    v_lshl_add_u32 v47, v13, 10, v47
    s_lshl_b32 s14, s11, 7
    v_add_u32 v25, s14, v47
    v_add_u32 v26, 7168, v25
    v_add_u32 v27, 14336, v25
    v_add_u32 v28, 21504, v25
    s_lshl_b32 s14, s11, 6
    v_add_lshl_u32 v47, v13, s14, 10
    v_add_u32 v29, v47, v45
    v_add_u32 v30, v47, v46
    v_add_u32 v30, 7168, v30
    v_add_u32 v31, v47, v45
    v_add_u32 v31, 14336, v31
    v_add_u32 v32, v47, v46
    v_add_u32 v32, 21504, v32
    v_bfe_u32 v3, v1, 2, 1
    v_lshlrev_b32 v3, 4, v3
    v_lshrrev_b32 v13, 3, v1
    v_lshl_add_u32 v3, v13, 2, v3
    v_and_b32 v13, 3, v1
    v_add_u32 v3, v3, v13
    v_bfe_u32 v13, v1, 1, 3
    v_xor_b32 v13, v13, v2
    v_lshlrev_b32 v14, 7, v1
    s_lshl_b32 s88, s9, 12
    v_xor_b32 v15, 0, v13
    v_lshl_add_u32 v4, v15, 4, v14
    v_add_u32 v8, s88, v4
    v_xor_b32 v15, 2, v13
    v_lshl_add_u32 v5, v15, 4, v14
    v_add_u32 v9, s88, v5
    v_xor_b32 v15, 4, v13
    v_lshl_add_u32 v6, v15, 4, v14
    v_add_u32 v10, s88, v6
    v_xor_b32 v15, 6, v13
    v_lshl_add_u32 v7, v15, 4, v14
    v_add_u32 v11, s88, v7
    v_bfe_u32 v13, v0, 2, 2
    v_lshl_add_u32 v13, v2, 3, v13
    v_mul_u32_u24 v13, 192, v13
    v_bfe_u32 v14, v0, 4, 1
    v_lshl_add_u32 v13, v14, 5, v13
    v_and_b32 v14, 3, v0
    v_lshl_add_u32 v12, v14, 3, v13
    v_mov_b32 v40, 0
    v_mov_b32 v42, 0
    v_mov_b32 v35, 0
    s_waitcnt lgkmcnt(0)
    s_mul_i32 s8, s8, 0x9E3779B1
    s_add_u32 s8, s8, 0x7F4A7C15
    v_mov_b32 v41, s8
    s_waitcnt vmcnt(11)
    v_dot2c_f32_bf16 v40, s100, v64
    v_dot2c_f32_bf16 v42, v64, v64
    v_dot2c_f32_bf16 v40, s100, v65
    v_dot2c_f32_bf16 v42, v65, v65
    v_dot2c_f32_bf16 v40, s100, v66
    v_dot2c_f32_bf16 v42, v66, v66
    v_dot2c_f32_bf16 v40, s100, v67
    v_dot2c_f32_bf16 v42, v67, v67
    v_dot2c_f32_bf16 v40, s100, v68
    v_dot2c_f32_bf16 v42, v68, v68
    v_dot2c_f32_bf16 v40, s100, v69
    v_dot2c_f32_bf16 v42, v69, v69
    v_dot2c_f32_bf16 v40, s100, v70
    v_dot2c_f32_bf16 v42, v70, v70
    v_dot2c_f32_bf16 v40, s100, v71
    v_dot2c_f32_bf16 v42, v71, v71
s_nop 1
    v_add_f32_dpp v40, v40, v40 quad_perm:[1,0,3,2] row_mask:0xf bank_mask:0xf
    v_add_f32_dpp v42, v42, v42 quad_perm:[1,0,3,2] row_mask:0xf bank_mask:0xf
s_nop 0
    v_add_f32_dpp v40, v40, v40 quad_perm:[2,3,0,1] row_mask:0xf bank_mask:0xf
    v_add_f32_dpp v42, v42, v42 quad_perm:[2,3,0,1] row_mask:0xf bank_mask:0xf
s_nop 0
    v_add_f32_dpp v40, v40, v40 row_half_mirror row_mask:0xf bank_mask:0xf
    v_add_f32_dpp v42, v42, v42 row_half_mirror row_mask:0xf bank_mask:0xf
s_nop 0
    v_add_f32_dpp v40, v40, v40 row_mirror row_mask:0xf bank_mask:0xf
    v_add_f32_dpp v42, v42, v42 row_mirror row_mask:0xf bank_mask:0xf
    v_mov_b32 v48, v40
    v_mov_b32 v49, v42
s_nop 0
    v_permlane16_swap_b32 v48, v40
    v_permlane16_swap_b32 v49, v42
    v_add_f32 v48, v48, v40
    v_add_f32 v49, v49, v42
    v_mul_f32 v48, 0x3b000000, v48
    v_mul_f32 v49, 0x3b000000, v49
    v_fma_f32 v49, -v48, v48, v49
    v_max_f32 v49, 0, v49
    v_cvt_pk_bf16_f32 v49, v49, v49
    v_lshlrev_b32 v49, 16, v49
    v_add_f32 v49, 0x3727c5ac, v49
    v_cvt_pk_bf16_f32 v49, v49, v49
    v_lshlrev_b32 v49, 16, v49
    v_sqrt_f32 v49, v49
    s_movk_i32 s14, 0x2000
    v_cvt_pk_bf16_f32 v40, -v48, v49
    s_mov_b32 exec_lo, 1
    s_mov_b32 exec_hi, 1
    buffer_store_dwordx2 v[40:41], v72, s[84:87], s14 offen sc1
    s_mov_b64 exec, -1
    s_lshr_b32 s14, s4, 3
    s_lshl1_add_u32 s14, s5, s14
    s_mul_i32 s90, s14, 12288
    s_add_u32 s90, s90, 0x8000
    s_mul_i32 s14, s9, 3072
    v_mul_u32_u24 v46, 1536, v2
    v_lshl_add_u32 v46, v1, 3, v46
    v_add_u32 v46, s14, v46
    s_lshl2_add_u32 s14, s4, s9
    s_lshl_b32 s14, s14, 8
    s_add_u32 s14, s14, 0x2000
    v_lshl_add_u32 v45, v3, 3, s14
    s_lshl_b32 s14, s10, 9
    s_add_u32 s14, s14, 0x2000
    v_lshl_add_u32 v44, v0, 3, s14
    s_mul_i32 s88, s9, 360448
    s_lshl_b32 s89, s9, 13
    s_lshl_b32 s91, s9, 12
    s_lshl_b32 s94, s93, 7
    s_mul_i32 s95, s93, 176128
    s_add_u32 m0, s92, s96
s_nop 0
    buffer_load_dwordx4 v16, s[48:51], s94 offen offset:0 lds
    buffer_load_dwordx4 v17, s[48:51], s94 offen offset:1024 lds
    buffer_load_dwordx4 v18, s[48:51], s94 offen offset:2048 lds
    buffer_load_dwordx4 v19, s[48:51], s94 offen offset:3072 lds
    s_add_u32 m0, s92, s97
s_nop 0
    buffer_load_dwordx4 v20, s[52:55], s94 offen offset:0 lds
    buffer_load_dwordx4 v21, s[52:55], s94 offen offset:1024 lds
    s_add_u32 m0, s92, s98
s_nop 0
    buffer_load_dwordx4 v22, s[56:59], s95 offen offset:0 lds
    buffer_load_dwordx4 v23, s[56:59], s95 offen offset:1024 lds
    buffer_load_dwordx4 v24, s[56:59], s95 offen offset:2048 lds
    s_add_u32 s93, s93, 1
    s_and_b32 s93, s93, 7
    s_add_u32 s92, s92, 36864
    s_cmp_eq_u32 s92, 110592
    s_cselect_b32 s92, 0, s92
    s_waitcnt vmcnt(12)
    s_barrier
    s_lshl_b32 s94, s93, 7
    s_mul_i32 s95, s93, 176128
    s_add_u32 m0, s92, s96
s_nop 0
    buffer_load_dwordx4 v16, s[48:51], s94 offen offset:0 lds
    buffer_load_dwordx4 v17, s[48:51], s94 offen offset:1024 lds
    buffer_load_dwordx4 v18, s[48:51], s94 offen offset:2048 lds
    buffer_load_dwordx4 v19, s[48:51], s94 offen offset:3072 lds
    s_add_u32 m0, s92, s97
s_nop 0
    buffer_load_dwordx4 v20, s[52:55], s94 offen offset:0 lds
    buffer_load_dwordx4 v21, s[52:55], s94 offen offset:1024 lds
    s_add_u32 m0, s92, s98
s_nop 0
    buffer_load_dwordx4 v22, s[56:59], s95 offen offset:0 lds
    buffer_load_dwordx4 v23, s[56:59], s95 offen offset:1024 lds
    buffer_load_dwordx4 v24, s[56:59], s95 offen offset:2048 lds
    s_add_u32 s93, s93, 1
    s_and_b32 s93, s93, 7
    s_add_u32 s92, s92, 36864
    s_cmp_eq_u32 s92, 110592
    s_cselect_b32 s92, 0, s92
    v_mov_b32 v40, 0
    v_mov_b32 v42, 0
    s_cmp_eq_u32 s9, 3
    s_cbranch_scc1 L_wsB
    s_lshl_b32 s14, s9, 6
    v_add_u32 v47, s14, v12
    ds_read_b64_tr_b16 v[48:49], v47 offset:24576
    ds_read_b64_tr_b16 v[50:51], v47 offset:25344
    ds_read_b64_tr_b16 v[52:53], v47 offset:27648
    ds_read_b64_tr_b16 v[54:55], v47 offset:28416
    ds_read_b64_tr_b16 v[56:57], v47 offset:30720
    ds_read_b64_tr_b16 v[58:59], v47 offset:31488
    ds_read_b64_tr_b16 v[60:61], v47 offset:33792
    ds_read_b64_tr_b16 v[62:63], v47 offset:34560
    s_lshl_b32 s14, s9, 8
    s_add_u32 s14, s14, 512
    s_mov_b32 s15, 0
    s_waitcnt lgkmcnt(0)
    s_branch L_wsC
L_wsB:
    ds_read_b128 v[48:51], v4 offset:16384
    ds_read_b128 v[52:55], v5 offset:16384
    ds_read_b128 v[56:59], v6 offset:16384
    ds_read_b128 v[60:63], v7 offset:16384
    ds_read_b128 v[64:67], v4 offset:20480
    ds_read_b128 v[68:71], v5 offset:20480
    ds_read_b128 v[72:75], v6 offset:20480
    ds_read_b128 v[76:79], v7 offset:20480
    s_mov_b32 s14, 0
    s_mov_b32 s15, -1
    s_waitcnt lgkmcnt(0)
    v_dot2c_f32_bf16 v42, s100, v64
    v_dot2c_f32_bf16 v42, s100, v65
    v_dot2c_f32_bf16 v42, s100, v66
    v_dot2c_f32_bf16 v42, s100, v67
    v_dot2c_f32_bf16 v42, s100, v68
    v_dot2c_f32_bf16 v42, s100, v69
    v_dot2c_f32_bf16 v42, s100, v70
    v_dot2c_f32_bf16 v42, s100, v71
    v_dot2c_f32_bf16 v42, s100, v72
    v_dot2c_f32_bf16 v42, s100, v73
    v_dot2c_f32_bf16 v42, s100, v74
    v_dot2c_f32_bf16 v42, s100, v75
    v_dot2c_f32_bf16 v42, s100, v76
    v_dot2c_f32_bf16 v42, s100, v77
    v_dot2c_f32_bf16 v42, s100, v78
    v_dot2c_f32_bf16 v42, s100, v79
L_wsC:
    v_dot2c_f32_bf16 v40, s100, v48
    v_dot2c_f32_bf16 v40, s100, v49
    v_dot2c_f32_bf16 v40, s100, v50
    v_dot2c_f32_bf16 v40, s100, v51
    v_dot2c_f32_bf16 v40, s100, v52
    v_dot2c_f32_bf16 v40, s100, v53
    v_dot2c_f32_bf16 v40, s100, v54
    v_dot2c_f32_bf16 v40, s100, v55
    v_dot2c_f32_bf16 v40, s100, v56
    v_dot2c_f32_bf16 v40, s100, v57
    v_dot2c_f32_bf16 v40, s100, v58
    v_dot2c_f32_bf16 v40, s100, v59
    v_dot2c_f32_bf16 v40, s100, v60
    v_dot2c_f32_bf16 v40, s100, v61
    v_dot2c_f32_bf16 v40, s100, v62
    v_dot2c_f32_bf16 v40, s100, v63
    v_lshl_add_u32 v47, v0, 3, s14
    s_mul_i32 s14, s12, 1536
    s_add_u32 s14, s14, s90
    v_permlane32_swap_b32 v40, v42
    v_add_f32 v40, v40, v42
    s_mov_b32 exec_hi, s15
    buffer_store_dwordx2 v[40:41], v47, s[84:87], s14 offen sc1
    s_mov_b64 exec, -1
    v_bfe_u32 v47, v0, 2, 2
    v_lshl_add_u32 v48, v2, 2, v47
    v_lshlrev_b32 v48, 7, v48
    v_lshrrev_b32 v47, 1, v47
    v_lshl_add_u32 v48, v47, 6, v48
    v_bfe_u32 v47, v0, 4, 1
    v_lshl_add_u32 v48, v47, 5, v48
    v_and_b32 v47, 3, v0
    v_lshl_add_u32 v4, v47, 3, v48
    v_xor_b32 v5, 64, v4
    s_waitcnt vmcnt(10)
    s_barrier
    s_lshl_b32 s94, s93, 7
    s_mul_i32 s95, s93, 176128
    s_add_u32 m0, s92, s96
s_nop 0
    buffer_load_dwordx4 v16, s[48:51], s94 offen offset:0 lds
    buffer_load_dwordx4 v17, s[48:51], s94 offen offset:1024 lds
    buffer_load_dwordx4 v18, s[48:51], s94 offen offset:2048 lds
    buffer_load_dwordx4 v19, s[48:51], s94 offen offset:3072 lds
    s_add_u32 m0, s92, s97
s_nop 0
    buffer_load_dwordx4 v20, s[52:55], s94 offen offset:0 lds
    buffer_load_dwordx4 v21, s[52:55], s94 offen offset:1024 lds
    s_add_u32 m0, s92, s98
s_nop 0
    buffer_load_dwordx4 v22, s[56:59], s95 offen offset:0 lds
    buffer_load_dwordx4 v23, s[56:59], s95 offen offset:1024 lds
    buffer_load_dwordx4 v24, s[56:59], s95 offen offset:2048 lds
    s_add_u32 s93, s93, 1
    s_and_b32 s93, s93, 7
    s_add_u32 s92, s92, 36864
    s_cmp_eq_u32 s92, 110592
    s_cselect_b32 s92, 0, s92
    s_waitcnt vmcnt(10)
    s_barrier
    s_lshl_b32 s94, s93, 7
    s_mul_i32 s95, s93, 176128
    s_add_u32 m0, s92, s96
s_nop 0
    buffer_load_dwordx4 v16, s[48:51], s94 offen offset:0 lds
    buffer_load_dwordx4 v17, s[48:51], s94 offen offset:1024 lds
    buffer_load_dwordx4 v18, s[48:51], s94 offen offset:2048 lds
    buffer_load_dwordx4 v19, s[48:51], s94 offen offset:3072 lds
    s_add_u32 m0, s92, s97
s_nop 0
    buffer_load_dwordx4 v20, s[52:55], s94 offen offset:0 lds
    buffer_load_dwordx4 v21, s[52:55], s94 offen offset:1024 lds
    s_add_u32 m0, s92, s98
s_nop 0
    buffer_load_dwordx4 v22, s[56:59], s95 offen offset:0 lds
    buffer_load_dwordx4 v23, s[56:59], s95 offen offset:1024 lds
    buffer_load_dwordx4 v24, s[56:59], s95 offen offset:2048 lds
    s_add_u32 s93, s93, 1
    s_and_b32 s93, s93, 7
    s_add_u32 s92, s92, 36864
    s_cmp_eq_u32 s92, 110592
    s_cselect_b32 s92, 0, s92
    s_waitcnt vmcnt(9)
    s_barrier
    s_lshl_b32 s94, s93, 7
    s_mul_i32 s95, s93, 176128
    s_add_u32 m0, s92, s96
s_nop 0
    buffer_load_dwordx4 v16, s[48:51], s94 offen offset:0 lds
    buffer_load_dwordx4 v17, s[48:51], s94 offen offset:1024 lds
    buffer_load_dwordx4 v18, s[48:51], s94 offen offset:2048 lds
    buffer_load_dwordx4 v19, s[48:51], s94 offen offset:3072 lds
    s_add_u32 m0, s92, s97
s_nop 0
    buffer_load_dwordx4 v20, s[52:55], s94 offen offset:0 lds
    buffer_load_dwordx4 v21, s[52:55], s94 offen offset:1024 lds
    s_add_u32 m0, s92, s98
s_nop 0
    buffer_load_dwordx4 v22, s[56:59], s95 offen offset:0 lds
    buffer_load_dwordx4 v23, s[56:59], s95 offen offset:1024 lds
    buffer_load_dwordx4 v24, s[56:59], s95 offen offset:2048 lds
    s_add_u32 s93, s93, 1
    s_and_b32 s93, s93, 7
    s_add_u32 s92, s92, 36864
    s_cmp_eq_u32 s92, 110592
    s_cselect_b32 s92, 0, s92
    s_waitcnt vmcnt(9)
    s_barrier
    s_lshl_b32 s94, s93, 7
    s_mul_i32 s95, s93, 176128
    s_add_u32 m0, s92, s96
s_nop 0
    buffer_load_dwordx4 v16, s[48:51], s94 offen offset:0 lds
    buffer_load_dwordx4 v17, s[48:51], s94 offen offset:1024 lds
    buffer_load_dwordx4 v18, s[48:51], s94 offen offset:2048 lds
    buffer_load_dwordx4 v19, s[48:51], s94 offen offset:3072 lds
    s_add_u32 m0, s92, s97
s_nop 0
    buffer_load_dwordx4 v20, s[52:55], s94 offen offset:0 lds
    buffer_load_dwordx4 v21, s[52:55], s94 offen offset:1024 lds
    s_add_u32 m0, s92, s98
s_nop 0
    buffer_load_dwordx4 v22, s[56:59], s95 offen offset:0 lds
    buffer_load_dwordx4 v23, s[56:59], s95 offen offset:1024 lds
    buffer_load_dwordx4 v24, s[56:59], s95 offen offset:2048 lds
    s_add_u32 s93, s93, 1
    s_and_b32 s93, s93, 7
    s_add_u32 s92, s92, 36864
    s_cmp_eq_u32 s92, 110592
    s_cselect_b32 s92, 0, s92
    buffer_load_dwordx2 v[48:49], v46, s[84:87], s90 offen offset:0 sc1
    buffer_load_dwordx2 v[50:51], v46, s[84:87], s90 offen offset:256 sc1
    buffer_load_dwordx2 v[52:53], v46, s[84:87], s90 offen offset:512 sc1
    buffer_load_dwordx2 v[54:55], v46, s[84:87], s90 offen offset:768 sc1
    buffer_load_dwordx2 v[56:57], v46, s[84:87], s90 offen offset:1024 sc1
    buffer_load_dwordx2 v[60:61], v45, s[84:87], 0 offen sc1
    buffer_load_dwordx2 v[74:75], v44, s[84:87], 0 offen sc1
    s_waitcnt vmcnt(16)
    s_barrier
    s_lshl_b32 s94, s93, 7
    s_mul_i32 s95, s93, 176128
    s_add_u32 m0, s92, s96
s_nop 0
    buffer_load_dwordx4 v16, s[48:51], s94 offen offset:0 lds
    buffer_load_dwordx4 v17, s[48:51], s94 offen offset:1024 lds
    buffer_load_dwordx4 v18, s[48:51], s94 offen offset:2048 lds
    buffer_load_dwordx4 v19, s[48:51], s94 offen offset:3072 lds
    s_add_u32 m0, s92, s97
s_nop 0
    buffer_load_dwordx4 v20, s[52:55], s94 offen offset:0 lds
    buffer_load_dwordx4 v21, s[52:55], s94 offen offset:1024 lds
    s_add_u32 m0, s92, s98
s_nop 0
    buffer_load_dwordx4 v22, s[56:59], s95 offen offset:0 lds
    buffer_load_dwordx4 v23, s[56:59], s95 offen offset:1024 lds
    buffer_load_dwordx4 v24, s[56:59], s95 offen offset:2048 lds
    s_add_u32 s93, s93, 1
    s_and_b32 s93, s93, 7
    s_add_u32 s92, s92, 36864
    s_cmp_eq_u32 s92, 110592
    s_cselect_b32 s92, 0, s92
    s_waitcnt vmcnt(16)
    s_barrier
    s_add_u32 s94, s44, 0
    s_sub_u32 s14, s94, s45
    s_min_u32 s94, s94, s14
    s_add_u32 s94, s88, s94
    s_add_u32 m0, s89, 110592
s_nop 0
    buffer_load_dwordx4 v25, s[60:63], s94 offen offset:0 lds
    buffer_load_dwordx4 v26, s[60:63], s94 offen offset:1024 lds
    buffer_load_dwordx4 v27, s[60:63], s94 offen offset:2048 lds
    buffer_load_dwordx4 v28, s[60:63], s94 offen offset:3072 lds
    s_add_u32 s94, s44, 32768
    s_sub_u32 s14, s94, s45
    s_min_u32 s94, s94, s14
    s_add_u32 s94, s88, s94
    s_add_u32 m0, s89, 114688
s_nop 0
    buffer_load_dwordx4 v25, s[60:63], s94 offen offset:0 lds
    buffer_load_dwordx4 v26, s[60:63], s94 offen offset:1024 lds
    buffer_load_dwordx4 v27, s[60:63], s94 offen offset:2048 lds
    buffer_load_dwordx4 v28, s[60:63], s94 offen offset:3072 lds
    s_cmp_eq_u32 s9, 0
    s_cselect_b32 s14, 0xffff, 0
    v_and_b32 v37, s14, v37
    v_and_b32 v39, s14, v39
    s_lshr_b32 s14, s9, 1
    s_lshl_b32 s14, s14, 9
    s_and_b32 s15, s9, 1
    s_lshl_b32 s15, s15, 3
    s_add_u32 s14, s14, s15
    s_add_u32 s14, s14, 106496
    v_lshl_add_u32 v62, v1, 4, s14
    v_lshl_add_u32 v62, v2, 10, v62
    v_add_u32 v63, 36864, v62
    s_lshl_b32 s14, s9, 7
    s_add_u32 s14, s14, 159744
    v_lshl_add_u32 v64, v3, 2, s14
    v_mov_b32 v58, 0
    s_mov_b32 s13, 0
    s_waitcnt vmcnt(17)
L_gchk:
    v_xor_b32 v65, s8, v61
    v_xor_b32 v66, s8, v75
    v_or_b32 v65, v65, v66
    v_xor_b32 v66, s8, v49
    v_or_b32 v65, v65, v66
    v_xor_b32 v66, s8, v51
    v_or_b32 v65, v65, v66
    v_xor_b32 v66, s8, v53
    v_or_b32 v65, v65, v66
    v_xor_b32 v66, s8, v55
    v_or_b32 v65, v65, v66
    v_xor_b32 v66, s8, v57
    v_or_b32 v65, v65, v66
    v_cmp_ne_u32 vcc, 0, v65
    s_cbranch_vccz L_gok
    s_add_u32 s13, s13, 1
    s_cmp_ge_u32 s13, 200000
    s_cbranch_scc1 L_gok
    buffer_load_dwordx2 v[48:49], v46, s[84:87], s90 offen offset:0 sc1
    buffer_load_dwordx2 v[50:51], v46, s[84:87], s90 offen offset:256 sc1
    buffer_load_dwordx2 v[52:53], v46, s[84:87], s90 offen offset:512 sc1
    buffer_load_dwordx2 v[54:55], v46, s[84:87], s90 offen offset:768 sc1
    buffer_load_dwordx2 v[56:57], v46, s[84:87], s90 offen offset:1024 sc1
    buffer_load_dwordx2 v[60:61], v45, s[84:87], 0 offen sc1
    buffer_load_dwordx2 v[74:75], v44, s[84:87], 0 offen sc1
    s_waitcnt vmcnt(0)
    s_branch L_gchk
L_gok:
    v_and_b32 v65, 0xffff0000, v60
    v_rcp_f32 v65, v65
    v_and_b32 v66, 0xffff0000, v74
    v_rcp_f32 v66, v66
    v_lshlrev_b32 v74, 16, v74
    v_lshlrev_b32 v75, 2, v0
    v_add_u32 v75, 160256, v75
    v_permlane32_swap_b32 v48, v50
    v_permlane32_swap_b32 v52, v54
    v_permlane32_swap_b32 v56, v58
    ds_write_b32 v64, v60 offset:3584
    ds_write_b32 v64, v65
    ds_write_b32 v75, v66
    ds_write_b32 v75, v74 offset:256
    v_add_f32 v48, v48, v50
    v_add_f32 v52, v52, v54
    v_add_f32 v56, v56, v58
    v_cvt_pk_bf16_f32 v50, v48, v48
    v_cvt_pk_bf16_f32 v54, v52, v52
    v_cvt_pk_bf16_f32 v58, v56, v56
    v_lshlrev_b32 v50, 16, v50
    v_lshlrev_b32 v54, 16, v54
    v_lshlrev_b32 v58, 16, v58
    v_sub_f32 v48, v48, v50
    v_sub_f32 v52, v52, v54
    v_sub_f32 v56, v56, v58
    v_cvt_pk_bf16_f32 v34, v50, v48
    v_cvt_pk_bf16_f32 v36, v54, v52
    v_cvt_pk_bf16_f32 v38, v58, v56
    ds_write_b64 v62, v[34:35] offset:0
    ds_write_b64 v62, v[36:37] offset:2048
    ds_write_b64 v63, v[38:39] offset:0
    s_waitcnt vmcnt(8)
    s_barrier
    s_add_u32 s94, s44, 65536
    s_sub_u32 s14, s94, s45
    s_min_u32 s94, s94, s14
    s_add_u32 s94, s88, s94
    s_add_u32 m0, s89, 73728
s_nop 0
    buffer_load_dwordx4 v25, s[60:63], s94 offen offset:0 lds
    buffer_load_dwordx4 v26, s[60:63], s94 offen offset:1024 lds
    buffer_load_dwordx4 v27, s[60:63], s94 offen offset:2048 lds
    buffer_load_dwordx4 v28, s[60:63], s94 offen offset:3072 lds
    s_add_u32 s94, s44, 98304
    s_sub_u32 s14, s94, s45
    s_min_u32 s94, s94, s14
    s_add_u32 s94, s88, s94
    s_add_u32 m0, s89, 77824
s_nop 0
    buffer_load_dwordx4 v25, s[60:63], s94 offen offset:0 lds
    buffer_load_dwordx4 v26, s[60:63], s94 offen offset:1024 lds
    buffer_load_dwordx4 v27, s[60:63], s94 offen offset:2048 lds
    buffer_load_dwordx4 v28, s[60:63], s94 offen offset:3072 lds
    s_waitcnt lgkmcnt(0)
    s_barrier
    s_add_u32 s94, s44, 131072
    s_sub_u32 s14, s94, s45
    s_min_u32 s94, s94, s14
    s_add_u32 s94, s88, s94
    s_add_u32 m0, s89, 0
s_nop 0
    buffer_load_dwordx4 v25, s[60:63], s94 offen offset:0 lds
    buffer_load_dwordx4 v26, s[60:63], s94 offen offset:1024 lds
    buffer_load_dwordx4 v27, s[60:63], s94 offen offset:2048 lds
    buffer_load_dwordx4 v28, s[60:63], s94 offen offset:3072 lds
    s_lshr_b32 s95, s17, 2
    s_lshl1_add_u32 s95, s9, s95
    s_lshl_b32 s95, s95, 7
    s_branch L_loader2
L_compute:
    s_waitcnt lgkmcnt(0)
    s_load_dword s8, s[46:47], 0
    s_mov_b32 s48, s16
    s_mov_b32 s49, s17
    s_mov_b32 s50, 0x200000
    s_mov_b32 s51, 0x20000
    v_and_b32 v13, 0x13, v1
    v_bfe_u32 v14, v1, 2, 1
    v_lshl_add_u32 v13, v14, 3, v13
    v_bfe_u32 v14, v1, 3, 1
    v_lshl_add_u32 v13, v14, 2, v13
    s_lshl_b32 s14, s5, 5
    v_add_lshl_u32 v13, v13, s14, 1
    global_load_ushort v228, v13, s[18:19]
    global_load_ushort v229, v13, s[20:21]
    global_load_ushort v230, v13, s[30:31]
    v_bfe_u32 v3, v1, 2, 1
    v_lshlrev_b32 v3, 4, v3
    v_lshrrev_b32 v13, 3, v1
    v_lshl_add_u32 v3, v13, 2, v3
    v_and_b32 v13, 3, v1
    v_add_u32 v3, v3, v13
    v_bfe_u32 v13, v1, 1, 3
    v_xor_b32 v13, v13, v2
    v_lshlrev_b32 v14, 7, v1
    s_lshl_b32 s88, s9, 12
    v_xor_b32 v15, 0, v13
    v_lshl_add_u32 v4, v15, 4, v14
    v_add_u32 v8, s88, v4
    v_xor_b32 v15, 2, v13
    v_lshl_add_u32 v5, v15, 4, v14
    v_add_u32 v9, s88, v5
    v_xor_b32 v15, 4, v13
    v_lshl_add_u32 v6, v15, 4, v14
    v_add_u32 v10, s88, v6
    v_xor_b32 v15, 6, v13
    v_lshl_add_u32 v7, v15, 4, v14
    v_add_u32 v11, s88, v7
    v_bfe_u32 v13, v0, 2, 2
    v_lshl_add_u32 v13, v2, 3, v13
    v_mul_u32_u24 v13, 192, v13
    v_bfe_u32 v14, v0, 4, 1
    v_lshl_add_u32 v13, v14, 5, v13
    v_and_b32 v14, 3, v0
    v_lshl_add_u32 v12, v14, 3, v13
    s_mov_b64 s[0:1], s[32:33]
    s_lshl1_add_u32 s17, s11, s10
    s_and_b32 s17, s17, 7
    s_mul_i32 s44, s17, 11
    s_lshr_b32 s44, s44, 3
    s_lshl_b32 s44, s44, 15
    s_cmp_eq_u32 s9, 3
    s_cselect_b32 s45, 10, 11
    s_lshl_b32 s45, s45, 15
    s_and_b32 s16, s17, 4
    s_bfe_u32 s14, s17, 0x10001
    s_or_b32 s16, s16, s14
    s_and_b32 s14, s17, 1
    s_lshl1_add_u32 s16, s14, s16
    s_lshl_b32 s16, s16, 11
    s_mov_b32 s60, s40
    s_mov_b32 s61, s41
    s_mov_b32 s62, 0x158000
    s_mov_b32 s63, 0x20000
    s_mov_b32 s64, s26
    s_mov_b32 s65, s27
    s_mov_b32 s66, 0x80000
    s_mov_b32 s67, 0x20000
    s_mov_b32 s68, s28
    s_mov_b32 s69, s29
    s_mov_b32 s70, 0x80000
    s_mov_b32 s71, 0x20000
    s_bitcmp1_b32 s17, 1
    s_cselect_b64 s[64:65], s[28:29], s[26:27]
    s_cselect_b64 s[68:69], s[26:27], s[28:29]
    s_add_u32 s72, s46, 0x100000
    s_addc_u32 s73, s47, 0
    s_mov_b32 s74, 0x980000
    s_mov_b32 s75, 0x20000
    s_mov_b32 s76, s42
    s_mov_b32 s77, s43
    s_mov_b32 s78, 0x400000
    s_mov_b32 s79, 0x20000
    s_lshl_b32 s14, s5, 13
    s_add_u32 s14, s14, 0x1000
    s_add_u32 s80, s46, s14
    s_addc_u32 s81, s47, 0
    s_mov_b32 s82, 0x2000
    s_mov_b32 s83, 0x20000
    s_add_u32 s84, s46, 0x40000
    s_addc_u32 s85, s47, 0
    s_mov_b32 s86, 0xb0000
    s_mov_b32 s87, 0x20000
    s_waitcnt lgkmcnt(0)
    s_lshl_b32 s14, s11, 7
    s_load_dword s101, s[0:1], s14
    s_lshl_b32 s14, s2, 2
    s_add_u32 s14, s14, s9
    s_mul_i32 s15, s14, 1408
    s_min_u32 s15, s15, 1407616
    s_lshl_b32 s14, s14, 9
    s_add_u32 s40, s40, s15
    s_addc_u32 s41, s41, 0
    s_load_dword s101, s[40:41], 0
    s_load_dword s101, s[40:41], 128
    s_load_dword s101, s[40:41], 256
    s_load_dword s101, s[40:41], 384
    s_load_dword s101, s[40:41], 512
    s_load_dword s101, s[40:41], 640
    s_load_dword s101, s[40:41], 768
    s_load_dword s101, s[40:41], 896
    s_load_dword s101, s[40:41], 1024
    s_load_dword s101, s[40:41], 1152
    s_load_dword s101, s[40:41], 1280
    s_add_u32 s26, s26, s14
    s_addc_u32 s27, s27, 0
    s_load_dword s101, s[26:27], 0
    s_load_dword s101, s[26:27], 128
    s_load_dword s101, s[26:27], 256
    s_load_dword s101, s[26:27], 384
    s_add_u32 s28, s28, s14
    s_addc_u32 s29, s29, 0
    s_load_dword s101, s[28:29], 0
    s_load_dword s101, s[28:29], 128
    s_load_dword s101, s[28:29], 256
    s_load_dword s101, s[28:29], 384
    v_mov_b32 v14, 0
    v_lshlrev_b32 v15, 2, v0
    v_add_u32 v15, 162816, v15
    ds_write_b32 v15, v14
    v_mov_b32 v16, 0
    v_mov_b32 v17, 0
    v_mov_b32 v18, 0
    v_mov_b32 v19, 0
    v_mov_b32 v20, 0
    v_mov_b32 v21, 0
    v_mov_b32 v22, 0
    v_mov_b32 v23, 0
    v_mov_b32 v24, 0
    v_mov_b32 v25, 0
    v_mov_b32 v26, 0
    v_mov_b32 v27, 0
    v_mov_b32 v28, 0
    v_mov_b32 v29, 0
    v_mov_b32 v30, 0
    v_mov_b32 v31, 0
    v_mov_b32 v32, 0
    v_mov_b32 v33, 0
    v_mov_b32 v34, 0
    v_mov_b32 v35, 0
    v_mov_b32 v36, 0
    v_mov_b32 v37, 0
    v_mov_b32 v38, 0
    v_mov_b32 v39, 0
    v_mov_b32 v40, 0
    v_mov_b32 v41, 0
    v_mov_b32 v42, 0
    v_mov_b32 v43, 0
    v_mov_b32 v44, 0
    v_mov_b32 v45, 0
    v_mov_b32 v46, 0
    v_mov_b32 v47, 0
    v_mov_b32 v48, 0
    v_mov_b32 v49, 0
    v_mov_b32 v50, 0
    v_mov_b32 v51, 0
    v_mov_b32 v52, 0
    v_mov_b32 v53, 0
    v_mov_b32 v54, 0
    v_mov_b32 v55, 0
    v_mov_b32 v56, 0
    v_mov_b32 v57, 0
    v_mov_b32 v58, 0
    v_mov_b32 v59, 0
    v_mov_b32 v60, 0
    v_mov_b32 v61, 0
    v_mov_b32 v62, 0
    v_mov_b32 v63, 0
    v_mov_b32 v64, 0
    v_mov_b32 v65, 0
    v_mov_b32 v66, 0
    v_mov_b32 v67, 0
    v_mov_b32 v68, 0
    v_mov_b32 v69, 0
    v_mov_b32 v70, 0
    v_mov_b32 v71, 0
    v_mov_b32 v72, 0
    v_mov_b32 v73, 0
    v_mov_b32 v74, 0
    v_mov_b32 v75, 0
    v_mov_b32 v76, 0
    v_mov_b32 v77, 0
    v_mov_b32 v78, 0
    v_mov_b32 v79, 0
    v_mov_b32 v80, 0
    v_mov_b32 v81, 0
    v_mov_b32 v82, 0
    v_mov_b32 v83, 0
    v_mov_b32 v84, 0
    v_mov_b32 v85, 0
    v_mov_b32 v86, 0
    v_mov_b32 v87, 0
    v_mov_b32 v88, 0
    v_mov_b32 v89, 0
    v_mov_b32 v90, 0
    v_mov_b32 v91, 0
    v_mov_b32 v92, 0
    v_mov_b32 v93, 0
    v_mov_b32 v94, 0
    v_mov_b32 v95, 0
    v_lshlrev_b32 v14, 4, v2
    v_sub_u32 v14, v3, v14
    v_mov_b32 v15, 0x3f80
    v_and_b32 v13, 1, v14
    v_lshlrev_b32 v13, 4, v13
    v_lshlrev_b32 v15, v13, v15
    v_lshrrev_b32 v14, 1, v14
    v_cmp_eq_u32 vcc, 0, v14
s_nop 1
    v_cndmask_b32 v188, 0, v15, vcc
    v_cmp_eq_u32 vcc, 1, v14
s_nop 1
    v_cndmask_b32 v189, 0, v15, vcc
    v_cmp_eq_u32 vcc, 2, v14
s_nop 1
    v_cndmask_b32 v190, 0, v15, vcc
    v_cmp_eq_u32 vcc, 3, v14
s_nop 1
    v_cndmask_b32 v191, 0, v15, vcc
    v_cmp_eq_u32 vcc, 4, v14
s_nop 1
    v_cndmask_b32 v192, 0, v15, vcc
    v_cmp_eq_u32 vcc, 5, v14
s_nop 1
    v_cndmask_b32 v193, 0, v15, vcc
    v_cmp_eq_u32 vcc, 6, v14
s_nop 1
    v_cndmask_b32 v194, 0, v15, vcc
    v_cmp_eq_u32 vcc, 7, v14
s_nop 1
    v_cndmask_b32 v195, 0, v15, vcc
    s_mul_i32 s8, s8, 0x9E3779B1
    s_add_u32 s8, s8, 0x7F4A7C15
    s_waitcnt vmcnt(0)
    v_lshlrev_b32 v228, 16, v228
    v_lshlrev_b32 v229, 16, v229
    v_lshlrev_b32 v230, 16, v230
    v_mul_f32 v230, 0x3fb8aa3b, v230
    v_exp_f32 v230, v230
s_nop 0
    v_cvt_pk_bf16_f32 v230, v230, v230
    v_lshlrev_b32 v230, 16, v230
    v_mul_f32 v232, v230, v228
    v_mul_f32 v233, v230, v229
    v_mul_f32 v232, 0x3fb8aa3b, v232
    v_exp_f32 v232, v232
    v_mul_f32 v233, 0.15915494, v233
    v_rndne_f32 v234, v233
    v_sub_f32 v233, v233, v234
    v_cos_f32 v234, v233
    v_sin_f32 v235, v233
    v_mul_f32 v144, v232, v234
    v_mul_f32 v145, v232, v235
    v_mul_f32 v236, v228, v228
    v_fmac_f32 v236, v229, v229
    v_rcp_f32 v236, v236
    v_add_f32 v232, -1.0, v144
    v_mov_b32 v233, v145
    v_add_f32 v236, v236, v236
    v_mul_f32 v234, v228, v236
    v_mul_f32 v235, -v229, v236
    v_pk_mul_f32 v[146:147], v[232:233], v[234:235] op_sel_hi:[1,0]
    v_pk_fma_f32 v[146:147], v[232:233], v[234:235], v[146:147] op_sel:[1,1,0] op_sel_hi:[0,1,1] neg_lo:[0,1,0]
    v_pk_mul_f32 v[156:157], v[146:147], v[144:145] op_sel_hi:[1,0]
    v_pk_fma_f32 v[156:157], v[146:147], v[144:145], v[156:157] op_sel:[1,1,0] op_sel_hi:[0,1,1] neg_lo:[0,1,0]
    v_pk_mul_f32 v[158:159], v[156:157], v[144:145] op_sel_hi:[1,0]
    v_pk_fma_f32 v[158:159], v[156:157], v[144:145], v[158:159] op_sel:[1,1,0] op_sel_hi:[0,1,1] neg_lo:[0,1,0]
    v_pk_mul_f32 v[160:161], v[158:159], v[144:145] op_sel_hi:[1,0]
    v_pk_fma_f32 v[160:161], v[158:159], v[144:145], v[160:161] op_sel:[1,1,0] op_sel_hi:[0,1,1] neg_lo:[0,1,0]
    v_pk_mul_f32 v[162:163], v[160:161], v[144:145] op_sel_hi:[1,0]
    v_pk_fma_f32 v[162:163], v[160:161], v[144:145], v[162:163] op_sel:[1,1,0] op_sel_hi:[0,1,1] neg_lo:[0,1,0]
    v_pk_mul_f32 v[164:165], v[162:163], v[144:145] op_sel_hi:[1,0]
    v_pk_fma_f32 v[164:165], v[162:163], v[144:145], v[164:165] op_sel:[1,1,0] op_sel_hi:[0,1,1] neg_lo:[0,1,0]
    v_pk_mul_f32 v[166:167], v[164:165], v[144:145] op_sel_hi:[1,0]
    v_pk_fma_f32 v[166:167], v[164:165], v[144:145], v[166:167] op_sel:[1,1,0] op_sel_hi:[0,1,1] neg_lo:[0,1,0]
    v_pk_mul_f32 v[168:169], v[166:167], v[144:145] op_sel_hi:[1,0]
    v_pk_fma_f32 v[168:169], v[166:167], v[144:145], v[168:169] op_sel:[1,1,0] op_sel_hi:[0,1,1] neg_lo:[0,1,0]
    v_pk_mul_f32 v[170:171], v[168:169], v[144:145] op_sel_hi:[1,0]
    v_pk_fma_f32 v[170:171], v[168:169], v[144:145], v[170:171] op_sel:[1,1,0] op_sel_hi:[0,1,1] neg_lo:[0,1,0]
    v_pk_mul_f32 v[172:173], v[170:171], v[144:145] op_sel_hi:[1,0]
    v_pk_fma_f32 v[172:173], v[170:171], v[144:145], v[172:173] op_sel:[1,1,0] op_sel_hi:[0,1,1] neg_lo:[0,1,0]
    v_pk_mul_f32 v[174:175], v[172:173], v[144:145] op_sel_hi:[1,0]
    v_pk_fma_f32 v[174:175], v[172:173], v[144:145], v[174:175] op_sel:[1,1,0] op_sel_hi:[0,1,1] neg_lo:[0,1,0]
    v_pk_mul_f32 v[176:177], v[174:175], v[144:145] op_sel_hi:[1,0]
    v_pk_fma_f32 v[176:177], v[174:175], v[144:145], v[176:177] op_sel:[1,1,0] op_sel_hi:[0,1,1] neg_lo:[0,1,0]
    v_pk_mul_f32 v[178:179], v[176:177], v[144:145] op_sel_hi:[1,0]
    v_pk_fma_f32 v[178:179], v[176:177], v[144:145], v[178:179] op_sel:[1,1,0] op_sel_hi:[0,1,1] neg_lo:[0,1,0]
    v_pk_mul_f32 v[180:181], v[178:179], v[144:145] op_sel_hi:[1,0]
    v_pk_fma_f32 v[180:181], v[178:179], v[144:145], v[180:181] op_sel:[1,1,0] op_sel_hi:[0,1,1] neg_lo:[0,1,0]
    v_pk_mul_f32 v[182:183], v[180:181], v[144:145] op_sel_hi:[1,0]
    v_pk_fma_f32 v[182:183], v[180:181], v[144:145], v[182:183] op_sel:[1,1,0] op_sel_hi:[0,1,1] neg_lo:[0,1,0]
    v_pk_mul_f32 v[184:185], v[182:183], v[144:145] op_sel_hi:[1,0]
    v_pk_fma_f32 v[184:185], v[182:183], v[144:145], v[184:185] op_sel:[1,1,0] op_sel_hi:[0,1,1] neg_lo:[0,1,0]
    v_pk_mul_f32 v[186:187], v[184:185], v[144:145] op_sel_hi:[1,0]
    v_pk_fma_f32 v[186:187], v[184:185], v[144:145], v[186:187] op_sel:[1,1,0] op_sel_hi:[0,1,1] neg_lo:[0,1,0]
    v_pk_mul_f32 v[228:229], v[144:145], v[144:145] op_sel_hi:[1,0]
    v_pk_fma_f32 v[228:229], v[144:145], v[144:145], v[228:229] op_sel:[1,1,0] op_sel_hi:[0,1,1] neg_lo:[0,1,0]
    v_pk_mul_f32 v[230:231], v[228:229], v[228:229] op_sel_hi:[1,0]
    v_pk_fma_f32 v[230:231], v[228:229], v[228:229], v[230:231] op_sel:[1,1,0] op_sel_hi:[0,1,1] neg_lo:[0,1,0]
    v_pk_mul_f32 v[228:229], v[230:231], v[230:231] op_sel_hi:[1,0]
    v_pk_fma_f32 v[228:229], v[230:231], v[230:231], v[228:229] op_sel:[1,1,0] op_sel_hi:[0,1,1] neg_lo:[0,1,0]
    v_pk_mul_f32 v[148:149], v[228:229], v[228:229] op_sel_hi:[1,0]
    v_pk_fma_f32 v[148:149], v[228:229], v[228:229], v[148:149] op_sel:[1,1,0] op_sel_hi:[0,1,1] neg_lo:[0,1,0]
    v_pk_mul_f32 v[228:229], v[148:149], v[148:149] op_sel_hi:[1,0]
    v_pk_fma_f32 v[228:229], v[148:149], v[148:149], v[228:229] op_sel:[1,1,0] op_sel_hi:[0,1,1] neg_lo:[0,1,0]
    v_pk_mul_f32 v[230:231], v[228:229], v[228:229] op_sel_hi:[1,0]
    v_pk_fma_f32 v[230:231], v[228:229], v[228:229], v[230:231] op_sel:[1,1,0] op_sel_hi:[0,1,1] neg_lo:[0,1,0]
    v_pk_mul_f32 v[150:151], v[230:231], v[230:231] op_sel_hi:[1,0]
    v_pk_fma_f32 v[150:151], v[230:231], v[230:231], v[150:151] op_sel:[1,1,0] op_sel_hi:[0,1,1] neg_lo:[0,1,0]
    v_pk_mul_f32 v[152:153], v[150:151], v[150:151] op_sel_hi:[1,0]
    v_pk_fma_f32 v[152:153], v[150:151], v[150:151], v[152:153] op_sel:[1,1,0] op_sel_hi:[0,1,1] neg_lo:[0,1,0]
    v_cmp_eq_u32 vcc, 1, v2
s_nop 1
    v_cndmask_b32 v232, 1.0, v148, vcc
    v_cndmask_b32 v233, 0, v149, vcc
    s_bitcmp1_b32 s9, 0
    s_cselect_b64 vcc, -1, 0
    v_cndmask_b32 v228, 1.0, v228, vcc
    v_cndmask_b32 v229, 0, v229, vcc
    s_bitcmp1_b32 s9, 1
    s_cselect_b64 vcc, -1, 0
    v_cndmask_b32 v230, 1.0, v230, vcc
    v_cndmask_b32 v231, 0, v231, vcc
    v_pk_mul_f32 v[234:235], v[232:233], v[228:229] op_sel_hi:[1,0]
    v_pk_fma_f32 v[234:235], v[232:233], v[228:229], v[234:235] op_sel:[1,1,0] op_sel_hi:[0,1,1] neg_lo:[0,1,0]
    v_pk_mul_f32 v[154:155], v[234:235], v[230:231] op_sel_hi:[1,0]
    v_pk_fma_f32 v[154:155], v[234:235], v[230:231], v[154:155] op_sel:[1,1,0] op_sel_hi:[0,1,1] neg_lo:[0,1,0]
    v_lshlrev_b32 v13, 4, v0
    v_add_u32 v14, 106496, v13
    s_mov_b32 s92, 0x01000100
    v_cmp_eq_u32 vcc, 0, v2
s_nop 1
    v_cndmask_b32 v246, 0, -1, vcc
    s_lshl_b32 s14, s9, 7
    s_add_u32 s14, s14, 159744
    v_lshl_add_u32 v15, v2, 6, s14
    v_lshl_add_u32 v245, v3, 2, s14
    s_mov_b32 s89, 0
    s_mov_b32 s91, 0
    s_waitcnt lgkmcnt(0)
    s_barrier
    ds_read_b128 v[96:99], v8 offset:0
    ds_read_b128 v[100:103], v4 offset:16384
    ds_read_b128 v[104:107], v4 offset:20480
    ds_read_b64_tr_b16 v[108:109], v12 offset:24576
    ds_read_b64_tr_b16 v[110:111], v12 offset:25344
    ds_read_b64_tr_b16 v[112:113], v12 offset:24640
    ds_read_b64_tr_b16 v[114:115], v12 offset:25408
    ds_read_b64_tr_b16 v[116:117], v12 offset:24704
    ds_read_b64_tr_b16 v[118:119], v12 offset:25472
L_cloop:
    s_waitcnt lgkmcnt(7)
    v_mfma_f32_32x32x16_bf16 v[16:31], v[96:99], v[100:103], v[16:31]
    ds_read_b128 v[120:123], v9 offset:0
    ds_read_b128 v[124:127], v5 offset:16384
    ds_read_b128 v[128:131], v5 offset:20480
    s_waitcnt lgkmcnt(9)
    v_mfma_f32_32x32x16_bf16 v[32:47], v[96:99], v[104:107], v[32:47]
    ds_read_b64_tr_b16 v[132:133], v12 offset:27648
    ds_read_b64_tr_b16 v[134:135], v12 offset:28416
    s_waitcnt lgkmcnt(9)
    v_mfma_f32_32x32x16_bf16 v[48:63], v[108:111], v[96:99], v[48:63]
    ds_read_b64_tr_b16 v[136:137], v12 offset:27712
    ds_read_b64_tr_b16 v[138:139], v12 offset:28480
    s_waitcnt lgkmcnt(9)
    v_mfma_f32_32x32x16_bf16 v[64:79], v[112:115], v[96:99], v[64:79]
    ds_read_b64_tr_b16 v[140:141], v12 offset:27776
    ds_read_b64_tr_b16 v[142:143], v12 offset:28544
    s_waitcnt lgkmcnt(9)
    v_mfma_f32_32x32x16_bf16 v[80:95], v[116:119], v[96:99], v[80:95]
    s_waitcnt lgkmcnt(7)
    v_mfma_f32_32x32x16_bf16 v[16:31], v[120:123], v[124:127], v[16:31]
    ds_read_b128 v[96:99], v10 offset:0
    ds_read_b128 v[100:103], v6 offset:16384
    ds_read_b128 v[104:107], v6 offset:20480
    s_waitcnt lgkmcnt(9)
    v_mfma_f32_32x32x16_bf16 v[32:47], v[120:123], v[128:131], v[32:47]
    ds_read_b64_tr_b16 v[108:109], v12 offset:30720
    ds_read_b64_tr_b16 v[110:111], v12 offset:31488
    s_waitcnt lgkmcnt(9)
    v_mfma_f32_32x32x16_bf16 v[48:63], v[132:135], v[120:123], v[48:63]
    ds_read_b64_tr_b16 v[112:113], v12 offset:30784
    ds_read_b64_tr_b16 v[114:115], v12 offset:31552
    s_waitcnt lgkmcnt(9)
    v_mfma_f32_32x32x16_bf16 v[64:79], v[136:139], v[120:123], v[64:79]
    ds_read_b64_tr_b16 v[116:117], v12 offset:30848
    ds_read_b64_tr_b16 v[118:119], v12 offset:31616
    s_waitcnt lgkmcnt(9)
    v_mfma_f32_32x32x16_bf16 v[80:95], v[140:143], v[120:123], v[80:95]
    s_waitcnt lgkmcnt(7)
    v_mfma_f32_32x32x16_bf16 v[16:31], v[96:99], v[100:103], v[16:31]
    ds_read_b128 v[120:123], v11 offset:0
    ds_read_b128 v[124:127], v7 offset:16384
    ds_read_b128 v[128:131], v7 offset:20480
    s_waitcnt lgkmcnt(9)
    v_mfma_f32_32x32x16_bf16 v[32:47], v[96:99], v[104:107], v[32:47]
    ds_read_b64_tr_b16 v[132:133], v12 offset:33792
    ds_read_b64_tr_b16 v[134:135], v12 offset:34560
    s_waitcnt lgkmcnt(9)
    v_mfma_f32_32x32x16_bf16 v[48:63], v[108:111], v[96:99], v[48:63]
    ds_read_b64_tr_b16 v[136:137], v12 offset:33856
    ds_read_b64_tr_b16 v[138:139], v12 offset:34624
    s_waitcnt lgkmcnt(9)
    v_mfma_f32_32x32x16_bf16 v[64:79], v[112:115], v[96:99], v[64:79]
    ds_read_b64_tr_b16 v[140:141], v12 offset:33920
    ds_read_b64_tr_b16 v[142:143], v12 offset:34688
    s_waitcnt lgkmcnt(9)
    v_mfma_f32_32x32x16_bf16 v[80:95], v[116:119], v[96:99], v[80:95]
    s_add_u32 s89, s89, 1
    s_cmp_eq_u32 s89, 3
    s_mov_b32 s90, 36864
    s_cmov_b32 s90, -73728
    s_cselect_b32 s89, 0, s89
    v_add_u32 v4, s90, v4
    v_add_u32 v5, s90, v5
    v_add_u32 v6, s90, v6
    v_add_u32 v7, s90, v7
    v_add_u32 v8, s90, v8
    v_add_u32 v9, s90, v9
    v_add_u32 v10, s90, v10
    v_add_u32 v11, s90, v11
    v_add_u32 v12, s90, v12
    s_add_u32 s91, s91, 1
    s_cmp_eq_u32 s91, 8
    s_waitcnt lgkmcnt(7)
    v_mfma_f32_32x32x16_bf16 v[16:31], v[120:123], v[124:127], v[16:31]
    s_cbranch_scc1 L_cdone
    s_waitcnt lgkmcnt(0)
    s_barrier
    ds_read_b128 v[96:99], v8 offset:0
    ds_read_b128 v[100:103], v4 offset:16384
    ds_read_b128 v[104:107], v4 offset:20480
    v_mfma_f32_32x32x16_bf16 v[32:47], v[120:123], v[128:131], v[32:47]
    ds_read_b64_tr_b16 v[108:109], v12 offset:24576
    ds_read_b64_tr_b16 v[110:111], v12 offset:25344
    v_mfma_f32_32x32x16_bf16 v[48:63], v[132:135], v[120:123], v[48:63]
    ds_read_b64_tr_b16 v[112:113], v12 offset:24640
    ds_read_b64_tr_b16 v[114:115], v12 offset:25408
    v_mfma_f32_32x32x16_bf16 v[64:79], v[136:139], v[120:123], v[64:79]
    ds_read_b64_tr_b16 v[116:117], v12 offset:24704
    ds_read_b64_tr_b16 v[118:119], v12 offset:25472
    v_mfma_f32_32x32x16_bf16 v[80:95], v[140:143], v[120:123], v[80:95]
    s_branch L_cloop
L_cdone:
    s_waitcnt lgkmcnt(0)
    s_barrier
    ds_read_b32 v247, v245 offset:3584
    ds_read_b128 v[100:103], v14 offset:0
    ds_read_b128 v[104:107], v14 offset:1024
    v_mfma_f32_32x32x16_bf16 v[32:47], v[120:123], v[128:131], v[32:47]
    ds_read_b128 v[228:231], v15 offset:0
    ds_read_b128 v[232:235], v15 offset:16
    ds_read_b128 v[236:239], v15 offset:32
    ds_read_b128 v[240:243], v15 offset:48
    v_mfma_f32_32x32x16_bf16 v[48:63], v[132:135], v[120:123], v[48:63]
    ds_read_b128 v[108:111], v14 offset:2048
    ds_read_b128 v[112:115], v14 offset:3072
    ds_read_b128 v[116:119], v14 offset:36864
    ds_read_b32 v244, v245
    s_waitcnt lgkmcnt(10)
    v_perm_b32 v96, v247, v247, s92
    v_lshrrev_b32 v247, 16, v247
    v_mov_b32 v99, 0
    v_mov_b32 v98, v96
    v_and_b32 v97, v246, v247
    v_mfma_f32_32x32x16_bf16 v[64:79], v[136:139], v[120:123], v[64:79]
    s_waitcnt lgkmcnt(8)
    v_mfma_f32_32x32x16_bf16 v[16:31], v[96:99], v[100:103], v[16:31]
    v_mfma_f32_32x32x16_bf16 v[32:47], v[96:99], v[104:107], v[32:47]
    v_mfma_f32_32x32x16_bf16 v[80:95], v[140:143], v[120:123], v[80:95]
    s_waitcnt lgkmcnt(0)
    v_mfma_f32_32x32x16_bf16 v[48:63], v[108:111], v[96:99], v[48:63]
    v_mfma_f32_32x32x16_bf16 v[64:79], v[112:115], v[96:99], v[64:79]
    v_mfma_f32_32x32x16_bf16 v[80:95], v[116:119], v[96:99], v[80:95]
s_nop 5
    v_mul_f32 v196, v228, v16
    v_mul_f32 v197, v228, v32
    v_mul_f32 v198, v229, v17
    v_mul_f32 v199, v229, v33
    v_mul_f32 v200, v230, v18
    v_mul_f32 v201, v230, v34
    v_mul_f32 v202, v231, v19
    v_mul_f32 v203, v231, v35
    v_mul_f32 v204, v232, v20
    v_mul_f32 v205, v232, v36
    v_mul_f32 v206, v233, v21
    v_mul_f32 v207, v233, v37
    v_mul_f32 v208, v234, v22
    v_mul_f32 v209, v234, v38
    v_mul_f32 v210, v235, v23
    v_mul_f32 v211, v235, v39
    v_mul_f32 v212, v236, v24
    v_mul_f32 v213, v236, v40
    v_mul_f32 v214, v237, v25
    v_mul_f32 v215, v237, v41
    v_mul_f32 v216, v238, v26
    v_mul_f32 v217, v238, v42
    v_mul_f32 v218, v239, v27
    v_mul_f32 v219, v239, v43
    v_mul_f32 v220, v240, v28
    v_mul_f32 v221, v240, v44
    v_mul_f32 v222, v241, v29
    v_mul_f32 v223, v241, v45
    v_mul_f32 v224, v242, v30
    v_mul_f32 v225, v242, v46
    v_mul_f32 v226, v243, v31
    v_mul_f32 v227, v243, v47
    v_pk_fma_f32 v[198:199], v[196:197], v[144:145], v[198:199] op_sel_hi:[1,0,1]
    v_pk_fma_f32 v[198:199], v[196:197], v[144:145], v[198:199] op_sel:[1,1,0] op_sel_hi:[0,1,1] neg_lo:[0,1,0]
    v_pk_fma_f32 v[200:201], v[198:199], v[144:145], v[200:201] op_sel_hi:[1,0,1]
    v_pk_fma_f32 v[200:201], v[198:199], v[144:145], v[200:201] op_sel:[1,1,0] op_sel_hi:[0,1,1] neg_lo:[0,1,0]
    v_pk_fma_f32 v[202:203], v[200:201], v[144:145], v[202:203] op_sel_hi:[1,0,1]
    v_pk_fma_f32 v[202:203], v[200:201], v[144:145], v[202:203] op_sel:[1,1,0] op_sel_hi:[0,1,1] neg_lo:[0,1,0]
    v_pk_fma_f32 v[204:205], v[202:203], v[144:145], v[204:205] op_sel_hi:[1,0,1]
    v_pk_fma_f32 v[204:205], v[202:203], v[144:145], v[204:205] op_sel:[1,1,0] op_sel_hi:[0,1,1] neg_lo:[0,1,0]
    v_pk_fma_f32 v[206:207], v[204:205], v[144:145], v[206:207] op_sel_hi:[1,0,1]
    v_pk_fma_f32 v[206:207], v[204:205], v[144:145], v[206:207] op_sel:[1,1,0] op_sel_hi:[0,1,1] neg_lo:[0,1,0]
    v_pk_fma_f32 v[208:209], v[206:207], v[144:145], v[208:209] op_sel_hi:[1,0,1]
    v_pk_fma_f32 v[208:209], v[206:207], v[144:145], v[208:209] op_sel:[1,1,0] op_sel_hi:[0,1,1] neg_lo:[0,1,0]
    v_pk_fma_f32 v[210:211], v[208:209], v[144:145], v[210:211] op_sel_hi:[1,0,1]
    v_pk_fma_f32 v[210:211], v[208:209], v[144:145], v[210:211] op_sel:[1,1,0] op_sel_hi:[0,1,1] neg_lo:[0,1,0]
    v_pk_fma_f32 v[212:213], v[210:211], v[144:145], v[212:213] op_sel_hi:[1,0,1]
    v_pk_fma_f32 v[212:213], v[210:211], v[144:145], v[212:213] op_sel:[1,1,0] op_sel_hi:[0,1,1] neg_lo:[0,1,0]
    v_pk_fma_f32 v[214:215], v[212:213], v[144:145], v[214:215] op_sel_hi:[1,0,1]
    v_pk_fma_f32 v[214:215], v[212:213], v[144:145], v[214:215] op_sel:[1,1,0] op_sel_hi:[0,1,1] neg_lo:[0,1,0]
    v_pk_fma_f32 v[216:217], v[214:215], v[144:145], v[216:217] op_sel_hi:[1,0,1]
    v_pk_fma_f32 v[216:217], v[214:215], v[144:145], v[216:217] op_sel:[1,1,0] op_sel_hi:[0,1,1] neg_lo:[0,1,0]
    v_pk_fma_f32 v[218:219], v[216:217], v[144:145], v[218:219] op_sel_hi:[1,0,1]
    v_pk_fma_f32 v[218:219], v[216:217], v[144:145], v[218:219] op_sel:[1,1,0] op_sel_hi:[0,1,1] neg_lo:[0,1,0]
    v_pk_fma_f32 v[220:221], v[218:219], v[144:145], v[220:221] op_sel_hi:[1,0,1]
    v_pk_fma_f32 v[220:221], v[218:219], v[144:145], v[220:221] op_sel:[1,1,0] op_sel_hi:[0,1,1] neg_lo:[0,1,0]
    v_pk_fma_f32 v[222:223], v[220:221], v[144:145], v[222:223] op_sel_hi:[1,0,1]
    v_pk_fma_f32 v[222:223], v[220:221], v[144:145], v[222:223] op_sel:[1,1,0] op_sel_hi:[0,1,1] neg_lo:[0,1,0]
    v_pk_fma_f32 v[224:225], v[222:223], v[144:145], v[224:225] op_sel_hi:[1,0,1]
    v_pk_fma_f32 v[224:225], v[222:223], v[144:145], v[224:225] op_sel:[1,1,0] op_sel_hi:[0,1,1] neg_lo:[0,1,0]
    v_pk_fma_f32 v[226:227], v[224:225], v[144:145], v[226:227] op_sel_hi:[1,0,1]
    v_pk_fma_f32 v[226:227], v[224:225], v[144:145], v[226:227] op_sel:[1,1,0] op_sel_hi:[0,1,1] neg_lo:[0,1,0]
    s_lshl_b32 s14, s9, 9
    s_add_u32 s14, s14, 160768
    v_lshl_add_u32 v13, v0, 3, s14
    ds_write_b64 v13, v[226:227]
    s_lshl_b32 s14, s9, 2
    s_add_u32 s14, s14, 162816
    v_mov_b32 v14, s14
    v_mov_b32 v15, 1
    ds_write_b32 v14, v15
    v_mov_b32 v14, 162816
    s_mov_b32 s13, 0
L_espin:
    ds_read_b128 v[96:99], v14 offset:0
    s_waitcnt lgkmcnt(0)
    v_and_b32 v96, v96, v97
    v_and_b32 v98, v98, v99
    v_and_b32 v96, v96, v98
s_nop 0
    v_readfirstlane_b32 s14, v96
    s_add_u32 s13, s13, 1
    s_cmp_lg_u32 s14, 0
    s_cbranch_scc1 L_espin_ok
    s_cmp_lt_u32 s13, 200000
    s_cbranch_scc1 L_espin
L_espin_ok:
    v_lshlrev_b32 v13, 3, v1
    v_add_u32 v13, 160768, v13
    ds_read_b64 v[96:97], v13 offset:0
    ds_read_b64 v[98:99], v13 offset:256
    ds_read_b64 v[100:101], v13 offset:512
    ds_read_b64 v[102:103], v13 offset:768
    ds_read_b64 v[104:105], v13 offset:1024
    ds_read_b64 v[106:107], v13 offset:1280
    ds_read_b64 v[108:109], v13 offset:1536
    ds_read_b64 v[110:111], v13 offset:1792
    s_lshl_b32 s14, s9, 1
    v_add_u32 v15, s14, v2
    v_mov_b32 v16, 0
    v_mov_b32 v17, 0
    s_waitcnt lgkmcnt(0)
    v_pk_fma_f32 v[98:99], v[96:97], v[148:149], v[98:99] op_sel_hi:[1,0,1]
    v_pk_fma_f32 v[98:99], v[96:97], v[148:149], v[98:99] op_sel:[1,1,0] op_sel_hi:[0,1,1] neg_lo:[0,1,0]
    v_pk_fma_f32 v[100:101], v[98:99], v[148:149], v[100:101] op_sel_hi:[1,0,1]
    v_pk_fma_f32 v[100:101], v[98:99], v[148:149], v[100:101] op_sel:[1,1,0] op_sel_hi:[0,1,1] neg_lo:[0,1,0]
    v_pk_fma_f32 v[102:103], v[100:101], v[148:149], v[102:103] op_sel_hi:[1,0,1]
    v_pk_fma_f32 v[102:103], v[100:101], v[148:149], v[102:103] op_sel:[1,1,0] op_sel_hi:[0,1,1] neg_lo:[0,1,0]
    v_pk_fma_f32 v[104:105], v[102:103], v[148:149], v[104:105] op_sel_hi:[1,0,1]
    v_pk_fma_f32 v[104:105], v[102:103], v[148:149], v[104:105] op_sel:[1,1,0] op_sel_hi:[0,1,1] neg_lo:[0,1,0]
    v_pk_fma_f32 v[106:107], v[104:105], v[148:149], v[106:107] op_sel_hi:[1,0,1]
    v_pk_fma_f32 v[106:107], v[104:105], v[148:149], v[106:107] op_sel:[1,1,0] op_sel_hi:[0,1,1] neg_lo:[0,1,0]
    v_pk_fma_f32 v[108:109], v[106:107], v[148:149], v[108:109] op_sel_hi:[1,0,1]
    v_pk_fma_f32 v[108:109], v[106:107], v[148:149], v[108:109] op_sel:[1,1,0] op_sel_hi:[0,1,1] neg_lo:[0,1,0]
    v_pk_fma_f32 v[110:111], v[108:109], v[148:149], v[110:111] op_sel_hi:[1,0,1]
    v_pk_fma_f32 v[110:111], v[108:109], v[148:149], v[110:111] op_sel:[1,1,0] op_sel_hi:[0,1,1] neg_lo:[0,1,0]
    s_cmp_lg_u32 s9, 0
    s_cbranch_scc1 L_nopub
    v_mov_b32 v112, v110
    v_mov_b32 v113, s8
    v_mov_b32 v114, v111
    v_mov_b32 v115, s8
    v_lshlrev_b32 v13, 4, v1
    s_sub_u32 s14, 15, s4
    s_lshl_b32 s14, s14, 9
    s_mov_b32 exec_hi, 0
    buffer_store_dwordx4 v[112:115], v13, s[80:83], s14 offen sc1
    s_mov_b64 exec, -1
L_nopub:
    v_cmp_eq_u32 vcc, 1, v15
s_nop 1
    v_cndmask_b32 v16, v16, v96, vcc
    v_cndmask_b32 v17, v17, v97, vcc
    v_cmp_eq_u32 vcc, 2, v15
s_nop 1
    v_cndmask_b32 v16, v16, v98, vcc
    v_cndmask_b32 v17, v17, v99, vcc
    v_cmp_eq_u32 vcc, 3, v15
s_nop 1
    v_cndmask_b32 v16, v16, v100, vcc
    v_cndmask_b32 v17, v17, v101, vcc
    v_cmp_eq_u32 vcc, 4, v15
s_nop 1
    v_cndmask_b32 v16, v16, v102, vcc
    v_cndmask_b32 v17, v17, v103, vcc
    v_cmp_eq_u32 vcc, 5, v15
s_nop 1
    v_cndmask_b32 v16, v16, v104, vcc
    v_cndmask_b32 v17, v17, v105, vcc
    v_cmp_eq_u32 vcc, 6, v15
s_nop 1
    v_cndmask_b32 v16, v16, v106, vcc
    v_cndmask_b32 v17, v17, v107, vcc
    v_cmp_eq_u32 vcc, 7, v15
s_nop 1
    v_cndmask_b32 v16, v16, v108, vcc
    v_cndmask_b32 v17, v17, v109, vcc
    v_mul_f32 v18, 0x3fb8aa3b, v244
    v_mul_f32 v20, -2.0, v244
    v_mov_b32 v22, v244
    v_lshlrev_b32 v24, 4, v0
    s_lshl_b32 s92, s4, 2
    s_add_u32 s92, s92, s9
    s_lshl_b32 s94, s92, 5
    s_add_u32 s94, s94, s5
    s_lshl_b32 s94, s94, 7
    s_add_u32 s94, s94, 0x70000
    s_mul_i32 s92, s92, 155648
    s_lshl_b32 s93, s6, 11
    s_add_u32 s93, s93, s92
    v_pk_mul_f32 v[96:97], v[48:49], v[18:19] op_sel_hi:[1,0]
    v_pk_mul_f32 v[98:99], v[50:51], v[18:19] op_sel_hi:[1,0]
    v_pk_mul_f32 v[100:101], v[52:53], v[18:19] op_sel_hi:[1,0]
    v_pk_mul_f32 v[102:103], v[54:55], v[18:19] op_sel_hi:[1,0]
    v_pk_mul_f32 v[104:105], v[56:57], v[18:19] op_sel_hi:[1,0]
    v_pk_mul_f32 v[106:107], v[58:59], v[18:19] op_sel_hi:[1,0]
    v_pk_mul_f32 v[108:109], v[60:61], v[18:19] op_sel_hi:[1,0]
    v_pk_mul_f32 v[110:111], v[62:63], v[18:19] op_sel_hi:[1,0]
    v_exp_f32 v96, v96
    v_exp_f32 v97, v97
    v_exp_f32 v98, v98
    v_exp_f32 v99, v99
    v_exp_f32 v100, v100
    v_exp_f32 v101, v101
    v_exp_f32 v102, v102
    v_exp_f32 v103, v103
    v_exp_f32 v104, v104
    v_exp_f32 v105, v105
    v_exp_f32 v106, v106
    v_exp_f32 v107, v107
    v_exp_f32 v108, v108
    v_exp_f32 v109, v109
    v_exp_f32 v110, v110
    v_exp_f32 v111, v111
    v_pk_add_f32 v[112:113], v[96:97], 2.0 op_sel_hi:[1,0]
    v_pk_add_f32 v[114:115], v[98:99], 2.0 op_sel_hi:[1,0]
    v_pk_add_f32 v[116:117], v[100:101], 2.0 op_sel_hi:[1,0]
    v_pk_add_f32 v[118:119], v[102:103], 2.0 op_sel_hi:[1,0]
    v_pk_add_f32 v[120:121], v[104:105], 2.0 op_sel_hi:[1,0]
    v_pk_add_f32 v[122:123], v[106:107], 2.0 op_sel_hi:[1,0]
    v_pk_add_f32 v[124:125], v[108:109], 2.0 op_sel_hi:[1,0]
    v_pk_add_f32 v[126:127], v[110:111], 2.0 op_sel_hi:[1,0]
    v_pk_fma_f32 v[96:97], v[96:97], v[112:113], 2.0 op_sel_hi:[1,1,0]
    v_pk_fma_f32 v[98:99], v[98:99], v[114:115], 2.0 op_sel_hi:[1,1,0]
    v_pk_fma_f32 v[100:101], v[100:101], v[116:117], 2.0 op_sel_hi:[1,1,0]
    v_pk_fma_f32 v[102:103], v[102:103], v[118:119], 2.0 op_sel_hi:[1,1,0]
    v_pk_fma_f32 v[104:105], v[104:105], v[120:121], 2.0 op_sel_hi:[1,1,0]
    v_pk_fma_f32 v[106:107], v[106:107], v[122:123], 2.0 op_sel_hi:[1,1,0]
    v_pk_fma_f32 v[108:109], v[108:109], v[124:125], 2.0 op_sel_hi:[1,1,0]
    v_pk_fma_f32 v[110:111], v[110:111], v[126:127], 2.0 op_sel_hi:[1,1,0]
    v_rcp_f32 v96, v96
    v_rcp_f32 v97, v97
    v_rcp_f32 v98, v98
    v_rcp_f32 v99, v99
    v_rcp_f32 v100, v100
    v_rcp_f32 v101, v101
    v_rcp_f32 v102, v102
    v_rcp_f32 v103, v103
    v_rcp_f32 v104, v104
    v_rcp_f32 v105, v105
    v_rcp_f32 v106, v106
    v_rcp_f32 v107, v107
    v_rcp_f32 v108, v108
    v_rcp_f32 v109, v109
    v_rcp_f32 v110, v110
    v_rcp_f32 v111, v111
    v_pk_fma_f32 v[96:97], v[96:97], v[20:21], v[22:23] op_sel_hi:[1,0,0]
    v_pk_fma_f32 v[98:99], v[98:99], v[20:21], v[22:23] op_sel_hi:[1,0,0]
    v_pk_fma_f32 v[100:101], v[100:101], v[20:21], v[22:23] op_sel_hi:[1,0,0]
    v_pk_fma_f32 v[102:103], v[102:103], v[20:21], v[22:23] op_sel_hi:[1,0,0]
    v_pk_fma_f32 v[104:105], v[104:105], v[20:21], v[22:23] op_sel_hi:[1,0,0]
    v_pk_fma_f32 v[106:107], v[106:107], v[20:21], v[22:23] op_sel_hi:[1,0,0]
    v_pk_fma_f32 v[108:109], v[108:109], v[20:21], v[22:23] op_sel_hi:[1,0,0]
    v_pk_fma_f32 v[110:111], v[110:111], v[20:21], v[22:23] op_sel_hi:[1,0,0]
    v_pk_mul_f32 v[96:97], v[96:97], v[48:49]
    v_pk_mul_f32 v[98:99], v[98:99], v[50:51]
    v_pk_mul_f32 v[100:101], v[100:101], v[52:53]
    v_pk_mul_f32 v[102:103], v[102:103], v[54:55]
    v_pk_mul_f32 v[104:105], v[104:105], v[56:57]
    v_pk_mul_f32 v[106:107], v[106:107], v[58:59]
    v_pk_mul_f32 v[108:109], v[108:109], v[60:61]
    v_pk_mul_f32 v[110:111], v[110:111], v[62:63]
    v_cvt_pk_bf16_f32 v128, v96, v97
    v_cvt_pk_bf16_f32 v129, v98, v99
    v_cvt_pk_bf16_f32 v130, v100, v101
    v_cvt_pk_bf16_f32 v131, v102, v103
    v_cvt_pk_bf16_f32 v132, v104, v105
    v_cvt_pk_bf16_f32 v133, v106, v107
    v_cvt_pk_bf16_f32 v134, v108, v109
    v_cvt_pk_bf16_f32 v135, v110, v111
    buffer_store_dwordx4 v[128:131], v24, s[72:75], s93 offen offset:0 sc1
    buffer_store_dwordx4 v[132:135], v24, s[72:75], s93 offen offset:1024 sc1
    v_pk_mul_f32 v[96:97], v[64:65], v[18:19] op_sel_hi:[1,0]
    v_pk_mul_f32 v[98:99], v[66:67], v[18:19] op_sel_hi:[1,0]
    v_pk_mul_f32 v[100:101], v[68:69], v[18:19] op_sel_hi:[1,0]
    v_pk_mul_f32 v[102:103], v[70:71], v[18:19] op_sel_hi:[1,0]
    v_pk_mul_f32 v[104:105], v[72:73], v[18:19] op_sel_hi:[1,0]
    v_pk_mul_f32 v[106:107], v[74:75], v[18:19] op_sel_hi:[1,0]
    v_pk_mul_f32 v[108:109], v[76:77], v[18:19] op_sel_hi:[1,0]
    v_pk_mul_f32 v[110:111], v[78:79], v[18:19] op_sel_hi:[1,0]
    v_exp_f32 v96, v96
    v_exp_f32 v97, v97
    v_exp_f32 v98, v98
    v_exp_f32 v99, v99
    v_exp_f32 v100, v100
    v_exp_f32 v101, v101
    v_exp_f32 v102, v102
    v_exp_f32 v103, v103
    v_exp_f32 v104, v104
    v_exp_f32 v105, v105
    v_exp_f32 v106, v106
    v_exp_f32 v107, v107
    v_exp_f32 v108, v108
    v_exp_f32 v109, v109
    v_exp_f32 v110, v110
    v_exp_f32 v111, v111
    v_pk_add_f32 v[112:113], v[96:97], 2.0 op_sel_hi:[1,0]
    v_pk_add_f32 v[114:115], v[98:99], 2.0 op_sel_hi:[1,0]
    v_pk_add_f32 v[116:117], v[100:101], 2.0 op_sel_hi:[1,0]
    v_pk_add_f32 v[118:119], v[102:103], 2.0 op_sel_hi:[1,0]
    v_pk_add_f32 v[120:121], v[104:105], 2.0 op_sel_hi:[1,0]
    v_pk_add_f32 v[122:123], v[106:107], 2.0 op_sel_hi:[1,0]
    v_pk_add_f32 v[124:125], v[108:109], 2.0 op_sel_hi:[1,0]
    v_pk_add_f32 v[126:127], v[110:111], 2.0 op_sel_hi:[1,0]
    v_pk_fma_f32 v[96:97], v[96:97], v[112:113], 2.0 op_sel_hi:[1,1,0]
    v_pk_fma_f32 v[98:99], v[98:99], v[114:115], 2.0 op_sel_hi:[1,1,0]
    v_pk_fma_f32 v[100:101], v[100:101], v[116:117], 2.0 op_sel_hi:[1,1,0]
    v_pk_fma_f32 v[102:103], v[102:103], v[118:119], 2.0 op_sel_hi:[1,1,0]
    v_pk_fma_f32 v[104:105], v[104:105], v[120:121], 2.0 op_sel_hi:[1,1,0]
    v_pk_fma_f32 v[106:107], v[106:107], v[122:123], 2.0 op_sel_hi:[1,1,0]
    v_pk_fma_f32 v[108:109], v[108:109], v[124:125], 2.0 op_sel_hi:[1,1,0]
    v_pk_fma_f32 v[110:111], v[110:111], v[126:127], 2.0 op_sel_hi:[1,1,0]
    v_rcp_f32 v96, v96
    v_rcp_f32 v97, v97
    v_rcp_f32 v98, v98
    v_rcp_f32 v99, v99
    v_rcp_f32 v100, v100
    v_rcp_f32 v101, v101
    v_rcp_f32 v102, v102
    v_rcp_f32 v103, v103
    v_rcp_f32 v104, v104
    v_rcp_f32 v105, v105
    v_rcp_f32 v106, v106
    v_rcp_f32 v107, v107
    v_rcp_f32 v108, v108
    v_rcp_f32 v109, v109
    v_rcp_f32 v110, v110
    v_rcp_f32 v111, v111
    v_pk_fma_f32 v[96:97], v[96:97], v[20:21], v[22:23] op_sel_hi:[1,0,0]
    v_pk_fma_f32 v[98:99], v[98:99], v[20:21], v[22:23] op_sel_hi:[1,0,0]
    v_pk_fma_f32 v[100:101], v[100:101], v[20:21], v[22:23] op_sel_hi:[1,0,0]
    v_pk_fma_f32 v[102:103], v[102:103], v[20:21], v[22:23] op_sel_hi:[1,0,0]
    v_pk_fma_f32 v[104:105], v[104:105], v[20:21], v[22:23] op_sel_hi:[1,0,0]
    v_pk_fma_f32 v[106:107], v[106:107], v[20:21], v[22:23] op_sel_hi:[1,0,0]
    v_pk_fma_f32 v[108:109], v[108:109], v[20:21], v[22:23] op_sel_hi:[1,0,0]
    v_pk_fma_f32 v[110:111], v[110:111], v[20:21], v[22:23] op_sel_hi:[1,0,0]
    v_pk_mul_f32 v[96:97], v[96:97], v[64:65]
    v_pk_mul_f32 v[98:99], v[98:99], v[66:67]
    v_pk_mul_f32 v[100:101], v[100:101], v[68:69]
    v_pk_mul_f32 v[102:103], v[102:103], v[70:71]
    v_pk_mul_f32 v[104:105], v[104:105], v[72:73]
    v_pk_mul_f32 v[106:107], v[106:107], v[74:75]
    v_pk_mul_f32 v[108:109], v[108:109], v[76:77]
    v_pk_mul_f32 v[110:111], v[110:111], v[78:79]
    v_cvt_pk_bf16_f32 v136, v96, v97
    v_cvt_pk_bf16_f32 v137, v98, v99
    v_cvt_pk_bf16_f32 v138, v100, v101
    v_cvt_pk_bf16_f32 v139, v102, v103
    v_cvt_pk_bf16_f32 v140, v104, v105
    v_cvt_pk_bf16_f32 v141, v106, v107
    v_cvt_pk_bf16_f32 v142, v108, v109
    v_cvt_pk_bf16_f32 v143, v110, v111
    buffer_store_dwordx4 v[136:139], v24, s[72:75], s93 offen offset:2048 sc1
    buffer_store_dwordx4 v[140:143], v24, s[72:75], s93 offen offset:3072 sc1
    s_cmp_lt_u32 s7, 3
    s_cbranch_scc1 L_no3
    v_pk_mul_f32 v[96:97], v[80:81], v[18:19] op_sel_hi:[1,0]
    v_pk_mul_f32 v[98:99], v[82:83], v[18:19] op_sel_hi:[1,0]
    v_pk_mul_f32 v[100:101], v[84:85], v[18:19] op_sel_hi:[1,0]
    v_pk_mul_f32 v[102:103], v[86:87], v[18:19] op_sel_hi:[1,0]
    v_pk_mul_f32 v[104:105], v[88:89], v[18:19] op_sel_hi:[1,0]
    v_pk_mul_f32 v[106:107], v[90:91], v[18:19] op_sel_hi:[1,0]
    v_pk_mul_f32 v[108:109], v[92:93], v[18:19] op_sel_hi:[1,0]
    v_pk_mul_f32 v[110:111], v[94:95], v[18:19] op_sel_hi:[1,0]
    v_exp_f32 v96, v96
    v_exp_f32 v97, v97
    v_exp_f32 v98, v98
    v_exp_f32 v99, v99
    v_exp_f32 v100, v100
    v_exp_f32 v101, v101
    v_exp_f32 v102, v102
    v_exp_f32 v103, v103
    v_exp_f32 v104, v104
    v_exp_f32 v105, v105
    v_exp_f32 v106, v106
    v_exp_f32 v107, v107
    v_exp_f32 v108, v108
    v_exp_f32 v109, v109
    v_exp_f32 v110, v110
    v_exp_f32 v111, v111
    v_pk_add_f32 v[112:113], v[96:97], 2.0 op_sel_hi:[1,0]
    v_pk_add_f32 v[114:115], v[98:99], 2.0 op_sel_hi:[1,0]
    v_pk_add_f32 v[116:117], v[100:101], 2.0 op_sel_hi:[1,0]
    v_pk_add_f32 v[118:119], v[102:103], 2.0 op_sel_hi:[1,0]
    v_pk_add_f32 v[120:121], v[104:105], 2.0 op_sel_hi:[1,0]
    v_pk_add_f32 v[122:123], v[106:107], 2.0 op_sel_hi:[1,0]
    v_pk_add_f32 v[124:125], v[108:109], 2.0 op_sel_hi:[1,0]
    v_pk_add_f32 v[126:127], v[110:111], 2.0 op_sel_hi:[1,0]
    v_pk_fma_f32 v[96:97], v[96:97], v[112:113], 2.0 op_sel_hi:[1,1,0]
    v_pk_fma_f32 v[98:99], v[98:99], v[114:115], 2.0 op_sel_hi:[1,1,0]
    v_pk_fma_f32 v[100:101], v[100:101], v[116:117], 2.0 op_sel_hi:[1,1,0]
    v_pk_fma_f32 v[102:103], v[102:103], v[118:119], 2.0 op_sel_hi:[1,1,0]
    v_pk_fma_f32 v[104:105], v[104:105], v[120:121], 2.0 op_sel_hi:[1,1,0]
    v_pk_fma_f32 v[106:107], v[106:107], v[122:123], 2.0 op_sel_hi:[1,1,0]
    v_pk_fma_f32 v[108:109], v[108:109], v[124:125], 2.0 op_sel_hi:[1,1,0]
    v_pk_fma_f32 v[110:111], v[110:111], v[126:127], 2.0 op_sel_hi:[1,1,0]
    v_rcp_f32 v96, v96
    v_rcp_f32 v97, v97
    v_rcp_f32 v98, v98
    v_rcp_f32 v99, v99
    v_rcp_f32 v100, v100
    v_rcp_f32 v101, v101
    v_rcp_f32 v102, v102
    v_rcp_f32 v103, v103
    v_rcp_f32 v104, v104
    v_rcp_f32 v105, v105
    v_rcp_f32 v106, v106
    v_rcp_f32 v107, v107
    v_rcp_f32 v108, v108
    v_rcp_f32 v109, v109
    v_rcp_f32 v110, v110
    v_rcp_f32 v111, v111
    v_pk_fma_f32 v[96:97], v[96:97], v[20:21], v[22:23] op_sel_hi:[1,0,0]
    v_pk_fma_f32 v[98:99], v[98:99], v[20:21], v[22:23] op_sel_hi:[1,0,0]
    v_pk_fma_f32 v[100:101], v[100:101], v[20:21], v[22:23] op_sel_hi:[1,0,0]
    v_pk_fma_f32 v[102:103], v[102:103], v[20:21], v[22:23] op_sel_hi:[1,0,0]
    v_pk_fma_f32 v[104:105], v[104:105], v[20:21], v[22:23] op_sel_hi:[1,0,0]
    v_pk_fma_f32 v[106:107], v[106:107], v[20:21], v[22:23] op_sel_hi:[1,0,0]
    v_pk_fma_f32 v[108:109], v[108:109], v[20:21], v[22:23] op_sel_hi:[1,0,0]
    v_pk_fma_f32 v[110:111], v[110:111], v[20:21], v[22:23] op_sel_hi:[1,0,0]
    v_pk_mul_f32 v[96:97], v[96:97], v[80:81]
    v_pk_mul_f32 v[98:99], v[98:99], v[82:83]
    v_pk_mul_f32 v[100:101], v[100:101], v[84:85]
    v_pk_mul_f32 v[102:103], v[102:103], v[86:87]
    v_pk_mul_f32 v[104:105], v[104:105], v[88:89]
    v_pk_mul_f32 v[106:107], v[106:107], v[90:91]
    v_pk_mul_f32 v[108:109], v[108:109], v[92:93]
    v_pk_mul_f32 v[110:111], v[110:111], v[94:95]
    v_cvt_pk_bf16_f32 v128, v96, v97
    v_cvt_pk_bf16_f32 v129, v98, v99
    v_cvt_pk_bf16_f32 v130, v100, v101
    v_cvt_pk_bf16_f32 v131, v102, v103
    v_cvt_pk_bf16_f32 v132, v104, v105
    v_cvt_pk_bf16_f32 v133, v106, v107
    v_cvt_pk_bf16_f32 v134, v108, v109
    v_cvt_pk_bf16_f32 v135, v110, v111
    s_add_u32 s93, s93, 4096
    buffer_store_dwordx4 v[128:131], v24, s[72:75], s93 offen offset:0 sc1
    buffer_store_dwordx4 v[132:135], v24, s[72:75], s93 offen offset:1024 sc1
L_no3:
    s_sub_u32 s14, s4, 1
    v_sub_u32 v26, s14, v2
    v_sub_u32 v25, 15, v26
    v_lshlrev_b32 v25, 9, v25
    v_lshl_add_u32 v25, v1, 4, v25
    v_add_u32 v23, 4096, v25
    buffer_load_dwordx4 v[48:51], v25, s[80:83], 0 offen offset:0 sc1
    buffer_load_dwordx4 v[52:55], v25, s[80:83], 0 offen offset:1024 sc1
    buffer_load_dwordx4 v[56:59], v25, s[80:83], 0 offen offset:2048 sc1
    buffer_load_dwordx4 v[60:63], v25, s[80:83], 0 offen offset:3072 sc1
    buffer_load_dwordx4 v[64:67], v23, s[80:83], 0 offen offset:0 sc1
    buffer_load_dwordx4 v[68:71], v23, s[80:83], 0 offen offset:1024 sc1
    buffer_load_dwordx4 v[72:75], v23, s[80:83], 0 offen offset:2048 sc1
    buffer_load_dwordx4 v[76:79], v23, s[80:83], 0 offen offset:3072 sc1
    v_pk_mul_f32 v[96:97], v[196:197], v[146:147] op_sel_hi:[1,0] neg_hi:[0,1]
    v_pk_fma_f32 v[96:97], v[196:197], v[146:147], v[96:97] op_sel:[1,1,0] op_sel_hi:[0,1,1] neg_lo:[0,1,0] neg_hi:[0,1,0]
    v_pk_mul_f32 v[98:99], v[198:199], v[146:147] op_sel_hi:[1,0] neg_hi:[0,1]
    v_pk_fma_f32 v[98:99], v[198:199], v[146:147], v[98:99] op_sel:[1,1,0] op_sel_hi:[0,1,1] neg_lo:[0,1,0] neg_hi:[0,1,0]
    v_pk_mul_f32 v[100:101], v[200:201], v[146:147] op_sel_hi:[1,0] neg_hi:[0,1]
    v_pk_fma_f32 v[100:101], v[200:201], v[146:147], v[100:101] op_sel:[1,1,0] op_sel_hi:[0,1,1] neg_lo:[0,1,0] neg_hi:[0,1,0]
    v_pk_mul_f32 v[102:103], v[202:203], v[146:147] op_sel_hi:[1,0] neg_hi:[0,1]
    v_pk_fma_f32 v[102:103], v[202:203], v[146:147], v[102:103] op_sel:[1,1,0] op_sel_hi:[0,1,1] neg_lo:[0,1,0] neg_hi:[0,1,0]
    v_pk_mul_f32 v[104:105], v[204:205], v[146:147] op_sel_hi:[1,0] neg_hi:[0,1]
    v_pk_fma_f32 v[104:105], v[204:205], v[146:147], v[104:105] op_sel:[1,1,0] op_sel_hi:[0,1,1] neg_lo:[0,1,0] neg_hi:[0,1,0]
    v_pk_mul_f32 v[106:107], v[206:207], v[146:147] op_sel_hi:[1,0] neg_hi:[0,1]
    v_pk_fma_f32 v[106:107], v[206:207], v[146:147], v[106:107] op_sel:[1,1,0] op_sel_hi:[0,1,1] neg_lo:[0,1,0] neg_hi:[0,1,0]
    v_pk_mul_f32 v[108:109], v[208:209], v[146:147] op_sel_hi:[1,0] neg_hi:[0,1]
    v_pk_fma_f32 v[108:109], v[208:209], v[146:147], v[108:109] op_sel:[1,1,0] op_sel_hi:[0,1,1] neg_lo:[0,1,0] neg_hi:[0,1,0]
    v_pk_mul_f32 v[110:111], v[210:211], v[146:147] op_sel_hi:[1,0] neg_hi:[0,1]
    v_pk_fma_f32 v[110:111], v[210:211], v[146:147], v[110:111] op_sel:[1,1,0] op_sel_hi:[0,1,1] neg_lo:[0,1,0] neg_hi:[0,1,0]
    v_pk_mul_f32 v[112:113], v[212:213], v[146:147] op_sel_hi:[1,0] neg_hi:[0,1]
    v_pk_fma_f32 v[112:113], v[212:213], v[146:147], v[112:113] op_sel:[1,1,0] op_sel_hi:[0,1,1] neg_lo:[0,1,0] neg_hi:[0,1,0]
    v_pk_mul_f32 v[114:115], v[214:215], v[146:147] op_sel_hi:[1,0] neg_hi:[0,1]
    v_pk_fma_f32 v[114:115], v[214:215], v[146:147], v[114:115] op_sel:[1,1,0] op_sel_hi:[0,1,1] neg_lo:[0,1,0] neg_hi:[0,1,0]
    v_pk_mul_f32 v[116:117], v[216:217], v[146:147] op_sel_hi:[1,0] neg_hi:[0,1]
    v_pk_fma_f32 v[116:117], v[216:217], v[146:147], v[116:117] op_sel:[1,1,0] op_sel_hi:[0,1,1] neg_lo:[0,1,0] neg_hi:[0,1,0]
    v_pk_mul_f32 v[118:119], v[218:219], v[146:147] op_sel_hi:[1,0] neg_hi:[0,1]
    v_pk_fma_f32 v[118:119], v[218:219], v[146:147], v[118:119] op_sel:[1,1,0] op_sel_hi:[0,1,1] neg_lo:[0,1,0] neg_hi:[0,1,0]
    v_pk_mul_f32 v[120:121], v[220:221], v[146:147] op_sel_hi:[1,0] neg_hi:[0,1]
    v_pk_fma_f32 v[120:121], v[220:221], v[146:147], v[120:121] op_sel:[1,1,0] op_sel_hi:[0,1,1] neg_lo:[0,1,0] neg_hi:[0,1,0]
    v_pk_mul_f32 v[122:123], v[222:223], v[146:147] op_sel_hi:[1,0] neg_hi:[0,1]
    v_pk_fma_f32 v[122:123], v[222:223], v[146:147], v[122:123] op_sel:[1,1,0] op_sel_hi:[0,1,1] neg_lo:[0,1,0] neg_hi:[0,1,0]
    v_pk_mul_f32 v[124:125], v[224:225], v[146:147] op_sel_hi:[1,0] neg_hi:[0,1]
    v_pk_fma_f32 v[124:125], v[224:225], v[146:147], v[124:125] op_sel:[1,1,0] op_sel_hi:[0,1,1] neg_lo:[0,1,0] neg_hi:[0,1,0]
    v_pk_mul_f32 v[126:127], v[226:227], v[146:147] op_sel_hi:[1,0] neg_hi:[0,1]
    v_pk_fma_f32 v[126:127], v[226:227], v[146:147], v[126:127] op_sel:[1,1,0] op_sel_hi:[0,1,1] neg_lo:[0,1,0] neg_hi:[0,1,0]
    v_mov_b32 v80, s8
    v_mov_b32 v81, s8
    v_mov_b32 v82, s8
    v_mov_b32 v83, s8
    s_lshl_b32 s14, s9, 2
    s_add_u32 s14, s14, 162832
    v_mov_b32 v14, s14
    v_mov_b32 v15, 1
    s_waitcnt vmcnt(8)
    s_mov_b64 exec, 0xff
    buffer_store_dwordx4 v[80:83], v24, s[84:87], s94 offen sc1
    s_mov_b64 exec, -1
    s_mov_b32 s13, 0
    s_waitcnt vmcnt(1)
L_aggchk:
    v_mov_b32 v29, 0
    v_xor_b32 v30, s8, v49
    v_xor_b32 v31, s8, v51
    v_cmp_le_i32 vcc, 0, v26
    v_or_b32 v30, v30, v31
s_nop 0
    v_cndmask_b32 v30, 0, v30, vcc
    v_or_b32 v29, v29, v30
    v_xor_b32 v30, s8, v53
    v_xor_b32 v31, s8, v55
    v_cmp_le_i32 vcc, 2, v26
    v_or_b32 v30, v30, v31
s_nop 0
    v_cndmask_b32 v30, 0, v30, vcc
    v_or_b32 v29, v29, v30
    v_xor_b32 v30, s8, v57
    v_xor_b32 v31, s8, v59
    v_cmp_le_i32 vcc, 4, v26
    v_or_b32 v30, v30, v31
s_nop 0
    v_cndmask_b32 v30, 0, v30, vcc
    v_or_b32 v29, v29, v30
    v_xor_b32 v30, s8, v61
    v_xor_b32 v31, s8, v63
    v_cmp_le_i32 vcc, 6, v26
    v_or_b32 v30, v30, v31
s_nop 0
    v_cndmask_b32 v30, 0, v30, vcc
    v_or_b32 v29, v29, v30
    v_xor_b32 v30, s8, v65
    v_xor_b32 v31, s8, v67
    v_cmp_le_i32 vcc, 8, v26
    v_or_b32 v30, v30, v31
s_nop 0
    v_cndmask_b32 v30, 0, v30, vcc
    v_or_b32 v29, v29, v30
    v_xor_b32 v30, s8, v69
    v_xor_b32 v31, s8, v71
    v_cmp_le_i32 vcc, 10, v26
    v_or_b32 v30, v30, v31
s_nop 0
    v_cndmask_b32 v30, 0, v30, vcc
    v_or_b32 v29, v29, v30
    v_xor_b32 v30, s8, v73
    v_xor_b32 v31, s8, v75
    v_cmp_le_i32 vcc, 12, v26
    v_or_b32 v30, v30, v31
s_nop 0
    v_cndmask_b32 v30, 0, v30, vcc
    v_or_b32 v29, v29, v30
    v_xor_b32 v30, s8, v77
    v_xor_b32 v31, s8, v79
    v_cmp_le_i32 vcc, 14, v26
    v_or_b32 v30, v30, v31
s_nop 0
    v_cndmask_b32 v30, 0, v30, vcc
    v_or_b32 v29, v29, v30
    v_cmp_ne_u32 vcc, 0, v29
    s_cbranch_vccz L_aggok
    s_add_u32 s13, s13, 1
    s_cmp_ge_u32 s13, 200000
    s_cbranch_scc1 L_aggok
    buffer_load_dwordx4 v[48:51], v25, s[80:83], 0 offen offset:0 sc1
    buffer_load_dwordx4 v[52:55], v25, s[80:83], 0 offen offset:1024 sc1
    buffer_load_dwordx4 v[56:59], v25, s[80:83], 0 offen offset:2048 sc1
    buffer_load_dwordx4 v[60:63], v25, s[80:83], 0 offen offset:3072 sc1
    buffer_load_dwordx4 v[64:67], v23, s[80:83], 0 offen offset:0 sc1
    buffer_load_dwordx4 v[68:71], v23, s[80:83], 0 offen offset:1024 sc1
    buffer_load_dwordx4 v[72:75], v23, s[80:83], 0 offen offset:2048 sc1
    buffer_load_dwordx4 v[76:79], v23, s[80:83], 0 offen offset:3072 sc1
    s_waitcnt vmcnt(0)
    s_branch L_aggchk
L_aggok:
    v_mov_b32 v49, v50
    v_mov_b32 v53, v54
    v_mov_b32 v57, v58
    v_mov_b32 v61, v62
    v_mov_b32 v65, v66
    v_mov_b32 v69, v70
    v_mov_b32 v73, v74
    v_mov_b32 v77, v78
    v_pk_fma_f32 v[72:73], v[76:77], v[152:153], v[72:73] op_sel_hi:[1,0,1]
    v_pk_fma_f32 v[72:73], v[76:77], v[152:153], v[72:73] op_sel:[1,1,0] op_sel_hi:[0,1,1] neg_lo:[0,1,0]
    v_pk_fma_f32 v[68:69], v[72:73], v[152:153], v[68:69] op_sel_hi:[1,0,1]
    v_pk_fma_f32 v[68:69], v[72:73], v[152:153], v[68:69] op_sel:[1,1,0] op_sel_hi:[0,1,1] neg_lo:[0,1,0]
    v_pk_fma_f32 v[64:65], v[68:69], v[152:153], v[64:65] op_sel_hi:[1,0,1]
    v_pk_fma_f32 v[64:65], v[68:69], v[152:153], v[64:65] op_sel:[1,1,0] op_sel_hi:[0,1,1] neg_lo:[0,1,0]
    v_pk_fma_f32 v[60:61], v[64:65], v[152:153], v[60:61] op_sel_hi:[1,0,1]
    v_pk_fma_f32 v[60:61], v[64:65], v[152:153], v[60:61] op_sel:[1,1,0] op_sel_hi:[0,1,1] neg_lo:[0,1,0]
    v_pk_fma_f32 v[56:57], v[60:61], v[152:153], v[56:57] op_sel_hi:[1,0,1]
    v_pk_fma_f32 v[56:57], v[60:61], v[152:153], v[56:57] op_sel:[1,1,0] op_sel_hi:[0,1,1] neg_lo:[0,1,0]
    v_pk_fma_f32 v[52:53], v[56:57], v[152:153], v[52:53] op_sel_hi:[1,0,1]
    v_pk_fma_f32 v[52:53], v[56:57], v[152:153], v[52:53] op_sel:[1,1,0] op_sel_hi:[0,1,1] neg_lo:[0,1,0]
    v_pk_fma_f32 v[48:49], v[52:53], v[152:153], v[48:49] op_sel_hi:[1,0,1]
    v_pk_fma_f32 v[48:49], v[52:53], v[152:153], v[48:49] op_sel:[1,1,0] op_sel_hi:[0,1,1] neg_lo:[0,1,0]
    v_mov_b32 v30, v48
    v_mov_b32 v31, v49
s_nop 0
    v_permlane32_swap_b32 v30, v48
    v_permlane32_swap_b32 v31, v49
    v_pk_fma_f32 v[30:31], v[48:49], v[150:151], v[30:31] op_sel_hi:[1,0,1]
    v_pk_fma_f32 v[30:31], v[48:49], v[150:151], v[30:31] op_sel:[1,1,0] op_sel_hi:[0,1,1] neg_lo:[0,1,0]
    v_pk_fma_f32 v[16:17], v[30:31], v[154:155], v[16:17] op_sel_hi:[1,0,1]
    v_pk_fma_f32 v[16:17], v[30:31], v[154:155], v[16:17] op_sel:[1,1,0] op_sel_hi:[0,1,1] neg_lo:[0,1,0]
    v_pk_fma_f32 v[96:97], v[156:157], v[16:17], v[96:97] op_sel_hi:[1,0,1] neg_hi:[0,1,0]
    v_pk_fma_f32 v[96:97], v[156:157], v[16:17], v[96:97] op_sel:[1,1,0] op_sel_hi:[0,1,1] neg_lo:[0,1,0] neg_hi:[0,1,0]
    v_pk_fma_f32 v[98:99], v[158:159], v[16:17], v[98:99] op_sel_hi:[1,0,1] neg_hi:[0,1,0]
    v_pk_fma_f32 v[98:99], v[158:159], v[16:17], v[98:99] op_sel:[1,1,0] op_sel_hi:[0,1,1] neg_lo:[0,1,0] neg_hi:[0,1,0]
    v_pk_fma_f32 v[100:101], v[160:161], v[16:17], v[100:101] op_sel_hi:[1,0,1] neg_hi:[0,1,0]
    v_pk_fma_f32 v[100:101], v[160:161], v[16:17], v[100:101] op_sel:[1,1,0] op_sel_hi:[0,1,1] neg_lo:[0,1,0] neg_hi:[0,1,0]
    v_pk_fma_f32 v[102:103], v[162:163], v[16:17], v[102:103] op_sel_hi:[1,0,1] neg_hi:[0,1,0]
    v_pk_fma_f32 v[102:103], v[162:163], v[16:17], v[102:103] op_sel:[1,1,0] op_sel_hi:[0,1,1] neg_lo:[0,1,0] neg_hi:[0,1,0]
    v_pk_fma_f32 v[104:105], v[164:165], v[16:17], v[104:105] op_sel_hi:[1,0,1] neg_hi:[0,1,0]
    v_pk_fma_f32 v[104:105], v[164:165], v[16:17], v[104:105] op_sel:[1,1,0] op_sel_hi:[0,1,1] neg_lo:[0,1,0] neg_hi:[0,1,0]
    v_pk_fma_f32 v[106:107], v[166:167], v[16:17], v[106:107] op_sel_hi:[1,0,1] neg_hi:[0,1,0]
    v_pk_fma_f32 v[106:107], v[166:167], v[16:17], v[106:107] op_sel:[1,1,0] op_sel_hi:[0,1,1] neg_lo:[0,1,0] neg_hi:[0,1,0]
    v_pk_fma_f32 v[108:109], v[168:169], v[16:17], v[108:109] op_sel_hi:[1,0,1] neg_hi:[0,1,0]
    v_pk_fma_f32 v[108:109], v[168:169], v[16:17], v[108:109] op_sel:[1,1,0] op_sel_hi:[0,1,1] neg_lo:[0,1,0] neg_hi:[0,1,0]
    v_pk_fma_f32 v[110:111], v[170:171], v[16:17], v[110:111] op_sel_hi:[1,0,1] neg_hi:[0,1,0]
    v_pk_fma_f32 v[110:111], v[170:171], v[16:17], v[110:111] op_sel:[1,1,0] op_sel_hi:[0,1,1] neg_lo:[0,1,0] neg_hi:[0,1,0]
    v_pk_fma_f32 v[112:113], v[172:173], v[16:17], v[112:113] op_sel_hi:[1,0,1] neg_hi:[0,1,0]
    v_pk_fma_f32 v[112:113], v[172:173], v[16:17], v[112:113] op_sel:[1,1,0] op_sel_hi:[0,1,1] neg_lo:[0,1,0] neg_hi:[0,1,0]
    v_pk_fma_f32 v[114:115], v[174:175], v[16:17], v[114:115] op_sel_hi:[1,0,1] neg_hi:[0,1,0]
    v_pk_fma_f32 v[114:115], v[174:175], v[16:17], v[114:115] op_sel:[1,1,0] op_sel_hi:[0,1,1] neg_lo:[0,1,0] neg_hi:[0,1,0]
    v_pk_fma_f32 v[116:117], v[176:177], v[16:17], v[116:117] op_sel_hi:[1,0,1] neg_hi:[0,1,0]
    v_pk_fma_f32 v[116:117], v[176:177], v[16:17], v[116:117] op_sel:[1,1,0] op_sel_hi:[0,1,1] neg_lo:[0,1,0] neg_hi:[0,1,0]
    v_pk_fma_f32 v[118:119], v[178:179], v[16:17], v[118:119] op_sel_hi:[1,0,1] neg_hi:[0,1,0]
    v_pk_fma_f32 v[118:119], v[178:179], v[16:17], v[118:119] op_sel:[1,1,0] op_sel_hi:[0,1,1] neg_lo:[0,1,0] neg_hi:[0,1,0]
    v_pk_fma_f32 v[120:121], v[180:181], v[16:17], v[120:121] op_sel_hi:[1,0,1] neg_hi:[0,1,0]
    v_pk_fma_f32 v[120:121], v[180:181], v[16:17], v[120:121] op_sel:[1,1,0] op_sel_hi:[0,1,1] neg_lo:[0,1,0] neg_hi:[0,1,0]
    v_pk_fma_f32 v[122:123], v[182:183], v[16:17], v[122:123] op_sel_hi:[1,0,1] neg_hi:[0,1,0]
    v_pk_fma_f32 v[122:123], v[182:183], v[16:17], v[122:123] op_sel:[1,1,0] op_sel_hi:[0,1,1] neg_lo:[0,1,0] neg_hi:[0,1,0]
    v_pk_fma_f32 v[124:125], v[184:185], v[16:17], v[124:125] op_sel_hi:[1,0,1] neg_hi:[0,1,0]
    v_pk_fma_f32 v[124:125], v[184:185], v[16:17], v[124:125] op_sel:[1,1,0] op_sel_hi:[0,1,1] neg_lo:[0,1,0] neg_hi:[0,1,0]
    v_pk_fma_f32 v[126:127], v[186:187], v[16:17], v[126:127] op_sel_hi:[1,0,1] neg_hi:[0,1,0]
    v_pk_fma_f32 v[126:127], v[186:187], v[16:17], v[126:127] op_sel:[1,1,0] op_sel_hi:[0,1,1] neg_lo:[0,1,0] neg_hi:[0,1,0]
    v_cvt_pk_bf16_f32 v32, v96, v98
    v_cvt_pk_bf16_f32 v33, v100, v102
    v_cvt_pk_bf16_f32 v34, v104, v106
    v_cvt_pk_bf16_f32 v35, v108, v110
    v_cvt_pk_bf16_f32 v36, v112, v114
    v_cvt_pk_bf16_f32 v37, v116, v118
    v_cvt_pk_bf16_f32 v38, v120, v122
    v_cvt_pk_bf16_f32 v39, v124, v126
    v_cvt_pk_bf16_f32 v40, v97, v99
    v_cvt_pk_bf16_f32 v41, v101, v103
    v_cvt_pk_bf16_f32 v42, v105, v107
    v_cvt_pk_bf16_f32 v43, v109, v111
    v_cvt_pk_bf16_f32 v44, v113, v115
    v_cvt_pk_bf16_f32 v45, v117, v119
    v_cvt_pk_bf16_f32 v46, v121, v123
    v_cvt_pk_bf16_f32 v47, v125, v127
    v_mfma_f32_32x32x16_bf16 v[48:63], v[32:35], v[188:191], 0
    v_mfma_f32_32x32x16_bf16 v[48:63], v[36:39], v[192:195], v[48:63]
    v_mfma_f32_32x32x16_bf16 v[64:79], v[40:43], v[188:191], 0
    v_mfma_f32_32x32x16_bf16 v[64:79], v[44:47], v[192:195], v[64:79]
    s_lshl_b32 s93, s5, 12
    s_add_u32 s93, s93, s92
    s_add_u32 s93, s93, 88064
s_nop 6
    v_cvt_pk_bf16_f32 v32, v48, v49
    v_cvt_pk_bf16_f32 v33, v50, v51
    v_cvt_pk_bf16_f32 v34, v52, v53
    v_cvt_pk_bf16_f32 v35, v54, v55
    v_cvt_pk_bf16_f32 v36, v56, v57
    v_cvt_pk_bf16_f32 v37, v58, v59
    v_cvt_pk_bf16_f32 v38, v60, v61
    v_cvt_pk_bf16_f32 v39, v62, v63
    buffer_store_dwordx4 v[32:35], v24, s[72:75], s93 offen offset:0 sc1
    buffer_store_dwordx4 v[36:39], v24, s[72:75], s93 offen offset:1024 sc1
    v_cvt_pk_bf16_f32 v40, v64, v65
    v_cvt_pk_bf16_f32 v41, v66, v67
    v_cvt_pk_bf16_f32 v42, v68, v69
    v_cvt_pk_bf16_f32 v43, v70, v71
    v_cvt_pk_bf16_f32 v44, v72, v73
    v_cvt_pk_bf16_f32 v45, v74, v75
    v_cvt_pk_bf16_f32 v46, v76, v77
    v_cvt_pk_bf16_f32 v47, v78, v79
    buffer_store_dwordx4 v[40:43], v24, s[72:75], s93 offen offset:2048 sc1
    buffer_store_dwordx4 v[44:47], v24, s[72:75], s93 offen offset:3072 sc1
    s_waitcnt vmcnt(0)
    s_mov_b64 exec, 0xff
    buffer_store_dwordx4 v[80:83], v24, s[84:87], s94 offen offset:2048 sc1
    s_mov_b64 exec, -1
    ds_write_b32 v14, v15 offset:32
    s_lshl_b32 s14, s9, 2
    s_add_u32 s14, s14, 162832
    v_mov_b32 v14, s14
    s_mov_b32 s13, 0
L_cspin:
    ds_read_b32 v15, v14 offset:0
    s_waitcnt lgkmcnt(0)
    v_readfirstlane_b32 s14, v15
    s_add_u32 s13, s13, 1
    s_cmp_lg_u32 s14, 0
    s_cbranch_scc1 L_cspin_ok
    s_sleep 2
    s_cmp_lt_u32 s13, 200000
    s_cbranch_scc1 L_cspin
L_cspin_ok:
    s_lshl_b32 s15, s9, 13
    s_sub_u32 s14, s15, 73728
    s_and_b32 s90, s17, 1
    s_lshl_b32 s90, s90, 6
    v_xor_b32 v4, s90, v4
    v_xor_b32 v5, s90, v5
    v_xor_b32 v6, s90, v6
    v_xor_b32 v7, s90, v7
    v_add_u32 v8, s15, v4
    v_add_u32 v4, s14, v4
    v_add_u32 v9, s15, v5
    v_add_u32 v5, s14, v5
    v_add_u32 v10, s15, v6
    v_add_u32 v6, s14, v6
    v_add_u32 v11, s15, v7
    v_add_u32 v7, s14, v7
    ds_read_b128 v[128:131], v4 offset:36864
    ds_read_b128 v[132:135], v4 offset:40960
    ds_read_b128 v[136:139], v5 offset:36864
    ds_read_b128 v[140:143], v5 offset:40960
    s_waitcnt lgkmcnt(4)
    ds_read_b128 v[144:147], v6 offset:36864
    ds_read_b128 v[148:151], v6 offset:40960
    ds_read_b128 v[152:155], v7 offset:36864
    ds_read_b128 v[156:159], v7 offset:40960
    s_waitcnt lgkmcnt(4)
    ds_read_b128 v[160:163], v8 offset:0
    ds_read_b128 v[164:167], v8 offset:4096
    ds_read_b128 v[168:171], v9 offset:0
    ds_read_b128 v[172:175], v9 offset:4096
    s_waitcnt lgkmcnt(4)
    ds_read_b128 v[176:179], v10 offset:0
    ds_read_b128 v[180:183], v10 offset:4096
    ds_read_b128 v[184:187], v11 offset:0
    ds_read_b128 v[188:191], v11 offset:4096
    s_waitcnt lgkmcnt(4)
    ds_read_b128 v[192:195], v8 offset:36864
    ds_read_b128 v[196:199], v8 offset:40960
    ds_read_b128 v[200:203], v9 offset:36864
    ds_read_b128 v[204:207], v9 offset:40960
    s_waitcnt lgkmcnt(4)
    ds_read_b128 v[208:211], v10 offset:36864
    ds_read_b128 v[212:215], v10 offset:40960
    ds_read_b128 v[216:219], v11 offset:36864
    ds_read_b128 v[220:223], v11 offset:40960
    s_waitcnt lgkmcnt(4)
    ds_read_b128 v[224:227], v4 offset:0
    ds_read_b128 v[228:231], v4 offset:4096
    ds_read_b128 v[232:235], v5 offset:0
    ds_read_b128 v[236:239], v5 offset:4096
    s_waitcnt lgkmcnt(4)
    ds_read_b128 v[240:243], v6 offset:0
    ds_read_b128 v[244:247], v6 offset:4096
    ds_read_b128 v[248:251], v7 offset:0
    ds_read_b128 v[252:255], v7 offset:4096
    s_waitcnt lgkmcnt(4)
    s_waitcnt lgkmcnt(0)
    v_mov_b32 v15, 1
    ds_write_b32 v14, v15 offset:16
    s_lshl_b32 s88, s9, 2
    s_mov_b32 s13, 0
L_hspin:
    ds_read_b32 v15, v14 offset:48
    s_waitcnt lgkmcnt(0)
    v_readfirstlane_b32 s14, v15
    s_add_u32 s13, s13, 1
    s_cmp_lg_u32 s14, 0
    s_cbranch_scc1 L_hspin_ok
    s_sleep 2
    s_cmp_lt_u32 s13, 200000
    s_cbranch_scc1 L_hspin
L_hspin_ok:
    v_and_b32 v14, 7, v0
    v_lshrrev_b32 v15, 3, v0
    v_lshl_add_u32 v14, v15, 5, v14
    v_lshlrev_b32 v14, 7, v14
    s_lshl4_add_u32 s15, s10, s9
    s_lshl_b32 s15, s15, 9
    s_add_u32 s15, s15, 0x70000
    s_movk_i32 s96, 0x0f0f
    s_mov_b32 exec_lo, s96
    s_mov_b32 exec_hi, 0
    s_mov_b32 s13, 0
L_hpoll:
    buffer_load_dword v15, v14, s[84:87], s15 offen offset:2048 sc1
    s_add_u32 s13, s13, 1
    s_waitcnt vmcnt(0)
    v_cmp_ne_u32 vcc, s8, v15
    s_cbranch_vccz L_hpoll_ok
    s_sleep 4
    s_cmp_lt_u32 s13, 200000
    s_cbranch_scc1 L_hpoll
L_hpoll_ok:
    s_mov_b64 exec, -1
    v_lshlrev_b32 v13, 4, v0
    s_mul_i32 s92, s10, 311296
    s_lshl_b32 s14, s9, 14
    s_add_u32 s92, s92, s14
    s_add_u32 s92, s92, 88064
    s_xor_b32 s93, s16, 0
    s_add_u32 s93, s93, s92
    s_add_u32 s94, s93, 155648
    buffer_load_dwordx4 v[16:19], v13, s[72:75], s93 offen offset:0 sc1
    buffer_load_dwordx4 v[20:23], v13, s[72:75], s94 offen offset:0 sc1
    buffer_load_dwordx4 v[24:27], v13, s[72:75], s93 offen offset:1024 sc1
    buffer_load_dwordx4 v[28:31], v13, s[72:75], s94 offen offset:1024 sc1
    s_xor_b32 s93, s16, 4096
    s_add_u32 s93, s93, s92
    s_add_u32 s94, s93, 155648
    buffer_load_dwordx4 v[32:35], v13, s[72:75], s93 offen offset:0 sc1
    buffer_load_dwordx4 v[36:39], v13, s[72:75], s94 offen offset:0 sc1
    buffer_load_dwordx4 v[40:43], v13, s[72:75], s93 offen offset:1024 sc1
    buffer_load_dwordx4 v[44:47], v13, s[72:75], s94 offen offset:1024 sc1
    s_xor_b32 s93, s16, 2048
    s_add_u32 s93, s93, s92
    s_add_u32 s94, s93, 155648
    buffer_load_dwordx4 v[48:51], v13, s[72:75], s93 offen offset:0 sc1
    buffer_load_dwordx4 v[52:55], v13, s[72:75], s94 offen offset:0 sc1
    buffer_load_dwordx4 v[56:59], v13, s[72:75], s93 offen offset:1024 sc1
    buffer_load_dwordx4 v[60:63], v13, s[72:75], s94 offen offset:1024 sc1
    s_waitcnt vmcnt(10)
    v_mfma_f32_32x32x16_bf16 v[64:79], v[16:19], v[128:131], 0
    v_mfma_f32_32x32x16_bf16 v[80:95], v[16:19], v[132:135], 0
    v_mfma_f32_32x32x16_bf16 v[96:111], v[20:23], v[128:131], 0
    v_mfma_f32_32x32x16_bf16 v[112:127], v[20:23], v[132:135], 0
    s_xor_b32 s93, s16, 6144
    s_add_u32 s93, s93, s92
    s_add_u32 s94, s93, 155648
    buffer_load_dwordx4 v[16:19], v13, s[72:75], s93 offen offset:0 sc1
    buffer_load_dwordx4 v[20:23], v13, s[72:75], s94 offen offset:0 sc1
    buffer_load_dwordx4 v[128:131], v13, s[72:75], s93 offen offset:1024 sc1
    buffer_load_dwordx4 v[132:135], v13, s[72:75], s94 offen offset:1024 sc1
    s_waitcnt vmcnt(12)
    v_mfma_f32_32x32x16_bf16 v[64:79], v[24:27], v[136:139], v[64:79]
    v_mfma_f32_32x32x16_bf16 v[80:95], v[24:27], v[140:143], v[80:95]
    v_mfma_f32_32x32x16_bf16 v[96:111], v[28:31], v[136:139], v[96:111]
    v_mfma_f32_32x32x16_bf16 v[112:127], v[28:31], v[140:143], v[112:127]
    s_xor_b32 s93, s16, 8192
    s_add_u32 s93, s93, s92
    s_add_u32 s94, s93, 155648
    buffer_load_dwordx4 v[24:27], v13, s[72:75], s93 offen offset:0 sc1
    buffer_load_dwordx4 v[28:31], v13, s[72:75], s94 offen offset:0 sc1
    buffer_load_dwordx4 v[136:139], v13, s[72:75], s93 offen offset:1024 sc1
    buffer_load_dwordx4 v[140:143], v13, s[72:75], s94 offen offset:1024 sc1
    s_waitcnt vmcnt(14)
    v_mfma_f32_32x32x16_bf16 v[64:79], v[32:35], v[144:147], v[64:79]
    v_mfma_f32_32x32x16_bf16 v[80:95], v[32:35], v[148:151], v[80:95]
    v_mfma_f32_32x32x16_bf16 v[96:111], v[36:39], v[144:147], v[96:111]
    v_mfma_f32_32x32x16_bf16 v[112:127], v[36:39], v[148:151], v[112:127]
    s_xor_b32 s93, s16, 12288
    s_add_u32 s93, s93, s92
    s_add_u32 s94, s93, 155648
    buffer_load_dwordx4 v[32:35], v13, s[72:75], s93 offen offset:0 sc1
    buffer_load_dwordx4 v[36:39], v13, s[72:75], s94 offen offset:0 sc1
    s_waitcnt vmcnt(14)
    v_mfma_f32_32x32x16_bf16 v[64:79], v[40:43], v[152:155], v[64:79]
    v_mfma_f32_32x32x16_bf16 v[80:95], v[40:43], v[156:159], v[80:95]
    v_mfma_f32_32x32x16_bf16 v[96:111], v[44:47], v[152:155], v[96:111]
    v_mfma_f32_32x32x16_bf16 v[112:127], v[44:47], v[156:159], v[112:127]
    buffer_load_dwordx4 v[144:147], v13, s[72:75], s93 offen offset:1024 sc1
    buffer_load_dwordx4 v[148:151], v13, s[72:75], s94 offen offset:1024 sc1
    s_waitcnt vmcnt(14)
    v_mfma_f32_32x32x16_bf16 v[64:79], v[48:51], v[160:163], v[64:79]
    v_mfma_f32_32x32x16_bf16 v[80:95], v[48:51], v[164:167], v[80:95]
    v_mfma_f32_32x32x16_bf16 v[96:111], v[52:55], v[160:163], v[96:111]
    v_mfma_f32_32x32x16_bf16 v[112:127], v[52:55], v[164:167], v[112:127]
    s_xor_b32 s93, s16, 10240
    s_add_u32 s93, s93, s92
    s_add_u32 s94, s93, 155648
    buffer_load_dwordx4 v[40:43], v13, s[72:75], s93 offen offset:0 sc1
    buffer_load_dwordx4 v[44:47], v13, s[72:75], s94 offen offset:0 sc1
    s_waitcnt vmcnt(14)
    v_mfma_f32_32x32x16_bf16 v[64:79], v[56:59], v[168:171], v[64:79]
    v_mfma_f32_32x32x16_bf16 v[80:95], v[56:59], v[172:175], v[80:95]
    v_mfma_f32_32x32x16_bf16 v[96:111], v[60:63], v[168:171], v[96:111]
    v_mfma_f32_32x32x16_bf16 v[112:127], v[60:63], v[172:175], v[112:127]
    buffer_load_dwordx4 v[152:155], v13, s[72:75], s93 offen offset:1024 sc1
    buffer_load_dwordx4 v[156:159], v13, s[72:75], s94 offen offset:1024 sc1
    s_waitcnt vmcnt(14)
    v_mfma_f32_32x32x16_bf16 v[64:79], v[16:19], v[176:179], v[64:79]
    v_mfma_f32_32x32x16_bf16 v[80:95], v[16:19], v[180:183], v[80:95]
    v_mfma_f32_32x32x16_bf16 v[96:111], v[20:23], v[176:179], v[96:111]
    v_mfma_f32_32x32x16_bf16 v[112:127], v[20:23], v[180:183], v[112:127]
    s_xor_b32 s93, s16, 14336
    s_add_u32 s93, s93, s92
    s_add_u32 s94, s93, 155648
    buffer_load_dwordx4 v[48:51], v13, s[72:75], s93 offen offset:0 sc1
    buffer_load_dwordx4 v[52:55], v13, s[72:75], s94 offen offset:0 sc1
    s_waitcnt vmcnt(14)
    v_mfma_f32_32x32x16_bf16 v[64:79], v[128:131], v[184:187], v[64:79]
    v_mfma_f32_32x32x16_bf16 v[80:95], v[128:131], v[188:191], v[80:95]
    v_mfma_f32_32x32x16_bf16 v[96:111], v[132:135], v[184:187], v[96:111]
    v_mfma_f32_32x32x16_bf16 v[112:127], v[132:135], v[188:191], v[112:127]
    buffer_load_dwordx4 v[160:163], v13, s[72:75], s93 offen offset:1024 sc1
    buffer_load_dwordx4 v[164:167], v13, s[72:75], s94 offen offset:1024 sc1
    s_waitcnt vmcnt(14)
    v_mfma_f32_32x32x16_bf16 v[64:79], v[24:27], v[192:195], v[64:79]
    v_mfma_f32_32x32x16_bf16 v[80:95], v[24:27], v[196:199], v[80:95]
    v_mfma_f32_32x32x16_bf16 v[96:111], v[28:31], v[192:195], v[96:111]
    v_mfma_f32_32x32x16_bf16 v[112:127], v[28:31], v[196:199], v[112:127]
    s_waitcnt vmcnt(12)
    v_mfma_f32_32x32x16_bf16 v[64:79], v[136:139], v[200:203], v[64:79]
    v_mfma_f32_32x32x16_bf16 v[80:95], v[136:139], v[204:207], v[80:95]
    v_mfma_f32_32x32x16_bf16 v[96:111], v[140:143], v[200:203], v[96:111]
    v_mfma_f32_32x32x16_bf16 v[112:127], v[140:143], v[204:207], v[112:127]
    s_waitcnt vmcnt(10)
    v_mfma_f32_32x32x16_bf16 v[64:79], v[32:35], v[208:211], v[64:79]
    v_mfma_f32_32x32x16_bf16 v[80:95], v[32:35], v[212:215], v[80:95]
    v_mfma_f32_32x32x16_bf16 v[96:111], v[36:39], v[208:211], v[96:111]
    v_mfma_f32_32x32x16_bf16 v[112:127], v[36:39], v[212:215], v[112:127]
    s_waitcnt vmcnt(8)
    v_mfma_f32_32x32x16_bf16 v[64:79], v[144:147], v[216:219], v[64:79]
    v_mfma_f32_32x32x16_bf16 v[80:95], v[144:147], v[220:223], v[80:95]
    v_mfma_f32_32x32x16_bf16 v[96:111], v[148:151], v[216:219], v[96:111]
    v_mfma_f32_32x32x16_bf16 v[112:127], v[148:151], v[220:223], v[112:127]
    s_lshl_b32 s14, s10, 6
    s_lshr_b32 s15, s9, 1
    s_lshl_b32 s15, s15, 5
    s_add_u32 s14, s14, s15
    s_lshr_b32 s15, s3, 2
    s_lshl_b32 s15, s15, 3
    s_add_u32 s91, s14, s15
    s_lshl_b32 s14, s11, 6
    s_and_b32 s15, s9, 1
    s_lshl_b32 s15, s15, 5
    s_add_u32 s14, s14, s15
    v_add_lshl_u32 v11, v1, s14, 1
    v_lshl_add_u32 v12, v2, 4, s91
    v_lshl_add_u32 v12, v12, 10, v11
    global_load_ushort v216, v11, s[0:1]
    s_movk_i32 s14, 0x1000
    buffer_load_ushort v208, v12, s[48:51], 0 offen offset:0
    buffer_load_ushort v209, v12, s[48:51], 0 offen offset:1024
    buffer_load_ushort v210, v12, s[48:51], 0 offen offset:2048
    buffer_load_ushort v211, v12, s[48:51], 0 offen offset:3072
    buffer_load_ushort v212, v12, s[48:51], s14 offen offset:0
    buffer_load_ushort v213, v12, s[48:51], s14 offen offset:1024
    buffer_load_ushort v214, v12, s[48:51], s14 offen offset:2048
    buffer_load_ushort v215, v12, s[48:51], s14 offen offset:3072
    s_lshl_b32 s14, s9, 13
    v_add_u32 v14, s14, v13
    s_waitcnt vmcnt(9)
    v_mfma_f32_32x32x16_bf16 v[64:79], v[40:43], v[224:227], v[64:79]
    v_mfma_f32_32x32x16_bf16 v[64:79], v[152:155], v[232:235], v[64:79]
    v_mfma_f32_32x32x16_bf16 v[64:79], v[48:51], v[240:243], v[64:79]
    v_mfma_f32_32x32x16_bf16 v[64:79], v[160:163], v[248:251], v[64:79]
    v_mfma_f32_32x32x16_bf16 v[80:95], v[40:43], v[228:231], v[80:95]
    v_mfma_f32_32x32x16_bf16 v[80:95], v[152:155], v[236:239], v[80:95]
s_nop 9
    ds_write_b128 v14, v[64:67] offset:0
    ds_write_b128 v14, v[76:79] offset:3072
    v_mfma_f32_32x32x16_bf16 v[80:95], v[48:51], v[244:247], v[80:95]
    ds_write_b128 v14, v[68:71] offset:1024
    v_mfma_f32_32x32x16_bf16 v[80:95], v[160:163], v[252:255], v[80:95]
    ds_write_b128 v14, v[72:75] offset:2048
    v_mfma_f32_32x32x16_bf16 v[96:111], v[44:47], v[224:227], v[96:111]
    v_mfma_f32_32x32x16_bf16 v[96:111], v[156:159], v[232:235], v[96:111]
s_nop 8
    ds_write_b128 v14, v[80:83] offset:4096
    ds_write_b128 v14, v[92:95] offset:7168
    v_mfma_f32_32x32x16_bf16 v[96:111], v[52:55], v[240:243], v[96:111]
    ds_write_b128 v14, v[84:87] offset:5120
    v_mfma_f32_32x32x16_bf16 v[96:111], v[164:167], v[248:251], v[96:111]
    ds_write_b128 v14, v[88:91] offset:6144
    v_mfma_f32_32x32x16_bf16 v[112:127], v[44:47], v[228:231], v[112:127]
    v_mfma_f32_32x32x16_bf16 v[112:127], v[156:159], v[236:239], v[112:127]
s_nop 8
    ds_write_b128 v14, v[96:99] offset:36864
    ds_write_b128 v14, v[108:111] offset:39936
    v_mfma_f32_32x32x16_bf16 v[112:127], v[52:55], v[244:247], v[112:127]
    ds_write_b128 v14, v[100:103] offset:37888
    v_mfma_f32_32x32x16_bf16 v[112:127], v[164:167], v[252:255], v[112:127]
    ds_write_b128 v14, v[104:107] offset:38912
s_nop 10
    ds_write_b128 v14, v[112:115] offset:40960
    ds_write_b128 v14, v[124:127] offset:44032
    ds_write_b128 v14, v[116:119] offset:41984
    ds_write_b128 v14, v[120:123] offset:43008
    s_branch L_final
L_loader2:
    s_xor_b32 s94, s95, 0
    s_add_u32 m0, s89, 36864
s_nop 0
    buffer_load_dwordx4 v29, s[64:67], s94 offen offset:0 lds
    buffer_load_dwordx4 v30, s[64:67], s94 offen offset:1024 lds
    buffer_load_dwordx4 v31, s[64:67], s94 offen offset:2048 lds
    buffer_load_dwordx4 v32, s[64:67], s94 offen offset:3072 lds
    s_xor_b32 s94, s95, 32768
    s_add_u32 m0, s89, 40960
s_nop 0
    buffer_load_dwordx4 v29, s[64:67], s94 offen offset:0 lds
    buffer_load_dwordx4 v30, s[64:67], s94 offen offset:1024 lds
    buffer_load_dwordx4 v31, s[64:67], s94 offen offset:2048 lds
    buffer_load_dwordx4 v32, s[64:67], s94 offen offset:3072 lds
    s_waitcnt vmcnt(20)
    s_add_u32 s14, s89, 110592
    v_add_u32 v6, s14, v4
    v_add_u32 v7, s14, v5
    ds_read_b64_tr_b16 v[112:113], v6 offset:0
    ds_read_b64_tr_b16 v[114:115], v6 offset:1024
    ds_read_b64_tr_b16 v[116:117], v7 offset:0
    ds_read_b64_tr_b16 v[118:119], v7 offset:1024
    ds_read_b64_tr_b16 v[120:121], v6 offset:2048
    ds_read_b64_tr_b16 v[122:123], v6 offset:3072
    ds_read_b64_tr_b16 v[124:125], v7 offset:2048
    ds_read_b64_tr_b16 v[126:127], v7 offset:3072
    s_waitcnt lgkmcnt(4)
    ds_read_b64_tr_b16 v[128:129], v6 offset:4096
    ds_read_b64_tr_b16 v[130:131], v6 offset:5120
    ds_read_b64_tr_b16 v[132:133], v7 offset:4096
    ds_read_b64_tr_b16 v[134:135], v7 offset:5120
    ds_read_b64_tr_b16 v[136:137], v6 offset:6144
    ds_read_b64_tr_b16 v[138:139], v6 offset:7168
    ds_read_b64_tr_b16 v[140:141], v7 offset:6144
    ds_read_b64_tr_b16 v[142:143], v7 offset:7168
    s_waitcnt lgkmcnt(0)
    s_add_u32 s94, s44, 163840
    s_sub_u32 s14, s94, s45
    s_min_u32 s94, s94, s14
    s_add_u32 s94, s88, s94
    s_add_u32 m0, s89, 110592
s_nop 0
    buffer_load_dwordx4 v25, s[60:63], s94 offen offset:0 lds
    buffer_load_dwordx4 v26, s[60:63], s94 offen offset:1024 lds
    buffer_load_dwordx4 v27, s[60:63], s94 offen offset:2048 lds
    buffer_load_dwordx4 v28, s[60:63], s94 offen offset:3072 lds
    s_add_u32 s94, s44, 196608
    s_sub_u32 s14, s94, s45
    s_min_u32 s94, s94, s14
    s_add_u32 s94, s88, s94
    s_add_u32 m0, s89, 114688
s_nop 0
    buffer_load_dwordx4 v25, s[60:63], s94 offen offset:0 lds
    buffer_load_dwordx4 v26, s[60:63], s94 offen offset:1024 lds
    buffer_load_dwordx4 v27, s[60:63], s94 offen offset:2048 lds
    buffer_load_dwordx4 v28, s[60:63], s94 offen offset:3072 lds
    s_waitcnt vmcnt(20)
    s_add_u32 s14, s89, 73728
    v_add_u32 v6, s14, v4
    v_add_u32 v7, s14, v5
    ds_read_b64_tr_b16 v[176:177], v6 offset:0
    ds_read_b64_tr_b16 v[178:179], v6 offset:1024
    ds_read_b64_tr_b16 v[180:181], v7 offset:0
    ds_read_b64_tr_b16 v[182:183], v7 offset:1024
    ds_read_b64_tr_b16 v[184:185], v6 offset:2048
    ds_read_b64_tr_b16 v[186:187], v6 offset:3072
    ds_read_b64_tr_b16 v[188:189], v7 offset:2048
    ds_read_b64_tr_b16 v[190:191], v7 offset:3072
    s_waitcnt lgkmcnt(4)
    ds_read_b64_tr_b16 v[192:193], v6 offset:4096
    ds_read_b64_tr_b16 v[194:195], v6 offset:5120
    ds_read_b64_tr_b16 v[196:197], v7 offset:4096
    ds_read_b64_tr_b16 v[198:199], v7 offset:5120
    ds_read_b64_tr_b16 v[200:201], v6 offset:6144
    ds_read_b64_tr_b16 v[202:203], v6 offset:7168
    ds_read_b64_tr_b16 v[204:205], v7 offset:6144
    ds_read_b64_tr_b16 v[206:207], v7 offset:7168
    s_waitcnt lgkmcnt(0)
    s_xor_b32 s94, s95, 0
    s_add_u32 m0, s89, 73728
s_nop 0
    buffer_load_dwordx4 v29, s[68:71], s94 offen offset:0 lds
    buffer_load_dwordx4 v30, s[68:71], s94 offen offset:1024 lds
    buffer_load_dwordx4 v31, s[68:71], s94 offen offset:2048 lds
    buffer_load_dwordx4 v32, s[68:71], s94 offen offset:3072 lds
    s_xor_b32 s94, s95, 32768
    s_add_u32 m0, s89, 77824
s_nop 0
    buffer_load_dwordx4 v29, s[68:71], s94 offen offset:0 lds
    buffer_load_dwordx4 v30, s[68:71], s94 offen offset:1024 lds
    buffer_load_dwordx4 v31, s[68:71], s94 offen offset:2048 lds
    buffer_load_dwordx4 v32, s[68:71], s94 offen offset:3072 lds
    s_waitcnt vmcnt(8)
    s_add_u32 s14, s89, 110592
    v_add_u32 v6, s14, v4
    v_add_u32 v7, s14, v5
    ds_read_b64_tr_b16 v[144:145], v6 offset:0
    ds_read_b64_tr_b16 v[146:147], v6 offset:1024
    ds_read_b64_tr_b16 v[148:149], v7 offset:0
    ds_read_b64_tr_b16 v[150:151], v7 offset:1024
    ds_read_b64_tr_b16 v[152:153], v6 offset:2048
    ds_read_b64_tr_b16 v[154:155], v6 offset:3072
    ds_read_b64_tr_b16 v[156:157], v7 offset:2048
    ds_read_b64_tr_b16 v[158:159], v7 offset:3072
    s_waitcnt lgkmcnt(4)
    ds_read_b64_tr_b16 v[160:161], v6 offset:4096
    ds_read_b64_tr_b16 v[162:163], v6 offset:5120
    ds_read_b64_tr_b16 v[164:165], v7 offset:4096
    ds_read_b64_tr_b16 v[166:167], v7 offset:5120
    ds_read_b64_tr_b16 v[168:169], v6 offset:6144
    ds_read_b64_tr_b16 v[170:171], v6 offset:7168
    ds_read_b64_tr_b16 v[172:173], v7 offset:6144
    ds_read_b64_tr_b16 v[174:175], v7 offset:7168
    s_waitcnt lgkmcnt(0)
    s_add_u32 s94, s44, 229376
    s_sub_u32 s14, s94, s45
    s_min_u32 s94, s94, s14
    s_add_u32 s94, s88, s94
    s_add_u32 m0, s89, 110592
s_nop 0
    buffer_load_dwordx4 v25, s[60:63], s94 offen offset:0 lds
    buffer_load_dwordx4 v26, s[60:63], s94 offen offset:1024 lds
    buffer_load_dwordx4 v27, s[60:63], s94 offen offset:2048 lds
    buffer_load_dwordx4 v28, s[60:63], s94 offen offset:3072 lds
    s_add_u32 s94, s44, 262144
    s_sub_u32 s14, s94, s45
    s_min_u32 s94, s94, s14
    s_add_u32 s94, s88, s94
    s_add_u32 m0, s89, 114688
s_nop 0
    buffer_load_dwordx4 v25, s[60:63], s94 offen offset:0 lds
    buffer_load_dwordx4 v26, s[60:63], s94 offen offset:1024 lds
    buffer_load_dwordx4 v27, s[60:63], s94 offen offset:2048 lds
    buffer_load_dwordx4 v28, s[60:63], s94 offen offset:3072 lds
    s_waitcnt vmcnt(32)
    s_add_u32 s14, s89, 0
    v_add_u32 v6, s14, v4
    v_add_u32 v7, s14, v5
    ds_read_b64_tr_b16 v[240:241], v6 offset:0
    ds_read_b64_tr_b16 v[242:243], v6 offset:1024
    ds_read_b64_tr_b16 v[244:245], v7 offset:0
    ds_read_b64_tr_b16 v[246:247], v7 offset:1024
    ds_read_b64_tr_b16 v[248:249], v6 offset:2048
    ds_read_b64_tr_b16 v[250:251], v6 offset:3072
    ds_read_b64_tr_b16 v[252:253], v7 offset:2048
    ds_read_b64_tr_b16 v[254:255], v7 offset:3072
    s_waitcnt lgkmcnt(0)
    s_xor_b32 s94, s95, 128
    s_add_u32 m0, s89, 0
s_nop 0
    buffer_load_dwordx4 v29, s[68:71], s94 offen offset:0 lds
    buffer_load_dwordx4 v30, s[68:71], s94 offen offset:1024 lds
    buffer_load_dwordx4 v31, s[68:71], s94 offen offset:2048 lds
    buffer_load_dwordx4 v32, s[68:71], s94 offen offset:3072 lds
    s_xor_b32 s94, s95, 32896
    s_add_u32 m0, s89, 4096
s_nop 0
    buffer_load_dwordx4 v29, s[68:71], s94 offen offset:0 lds
    buffer_load_dwordx4 v30, s[68:71], s94 offen offset:1024 lds
    buffer_load_dwordx4 v31, s[68:71], s94 offen offset:2048 lds
    buffer_load_dwordx4 v32, s[68:71], s94 offen offset:3072 lds
    s_waitcnt vmcnt(8)
    s_add_u32 s14, s89, 110592
    v_add_u32 v6, s14, v4
    v_add_u32 v7, s14, v5
    ds_read_b64_tr_b16 v[208:209], v6 offset:0
    ds_read_b64_tr_b16 v[210:211], v6 offset:1024
    ds_read_b64_tr_b16 v[212:213], v7 offset:0
    ds_read_b64_tr_b16 v[214:215], v7 offset:1024
    ds_read_b64_tr_b16 v[216:217], v6 offset:2048
    ds_read_b64_tr_b16 v[218:219], v6 offset:3072
    ds_read_b64_tr_b16 v[220:221], v7 offset:2048
    ds_read_b64_tr_b16 v[222:223], v7 offset:3072
    s_waitcnt lgkmcnt(4)
    ds_read_b64_tr_b16 v[224:225], v6 offset:4096
    ds_read_b64_tr_b16 v[226:227], v6 offset:5120
    ds_read_b64_tr_b16 v[228:229], v7 offset:4096
    ds_read_b64_tr_b16 v[230:231], v7 offset:5120
    ds_read_b64_tr_b16 v[232:233], v6 offset:6144
    ds_read_b64_tr_b16 v[234:235], v6 offset:7168
    ds_read_b64_tr_b16 v[236:237], v7 offset:6144
    ds_read_b64_tr_b16 v[238:239], v7 offset:7168
    s_waitcnt lgkmcnt(0)
    s_xor_b32 s94, s95, 128
    s_add_u32 m0, s89, 110592
s_nop 0
    buffer_load_dwordx4 v29, s[64:67], s94 offen offset:0 lds
    buffer_load_dwordx4 v30, s[64:67], s94 offen offset:1024 lds
    buffer_load_dwordx4 v31, s[64:67], s94 offen offset:2048 lds
    buffer_load_dwordx4 v32, s[64:67], s94 offen offset:3072 lds
    s_xor_b32 s94, s95, 32896
    s_add_u32 m0, s89, 114688
s_nop 0
    buffer_load_dwordx4 v29, s[64:67], s94 offen offset:0 lds
    buffer_load_dwordx4 v30, s[64:67], s94 offen offset:1024 lds
    buffer_load_dwordx4 v31, s[64:67], s94 offen offset:2048 lds
    buffer_load_dwordx4 v32, s[64:67], s94 offen offset:3072 lds
    s_mul_i32 s96, s9, 36864
    v_mov_b32 v14, 162816
    s_mov_b32 s13, 0
L_espin2:
    ds_read_b128 v[48:51], v14 offset:0
    s_waitcnt lgkmcnt(0)
    v_and_b32 v48, v48, v49
    v_and_b32 v50, v50, v51
    v_and_b32 v48, v48, v50
s_nop 0
    v_readfirstlane_b32 s14, v48
    s_add_u32 s13, s13, 1
    s_cmp_lg_u32 s14, 0
    s_cbranch_scc1 L_espin2_ok
    s_sleep 2
    s_cmp_lt_u32 s13, 200000
    s_cbranch_scc1 L_espin2
L_espin2_ok:
    s_add_u32 s94, s44, 294912
    s_sub_u32 s14, s94, s45
    s_min_u32 s94, s94, s14
    s_add_u32 s94, s88, s94
    s_add_u32 m0, s91, 143360
s_nop 0
    buffer_load_dwordx4 v25, s[60:63], s94 offen offset:0 lds
    buffer_load_dwordx4 v26, s[60:63], s94 offen offset:1024 lds
    buffer_load_dwordx4 v27, s[60:63], s94 offen offset:2048 lds
    buffer_load_dwordx4 v28, s[60:63], s94 offen offset:3072 lds
    s_cmp_eq_u32 s9, 3
    s_cbranch_scc1 L_nou10
    s_add_u32 s94, s44, 327680
    s_sub_u32 s14, s94, s45
    s_min_u32 s94, s94, s14
    s_add_u32 s94, s88, s94
    s_add_u32 m0, s96, 32768
s_nop 0
    buffer_load_dwordx4 v25, s[60:63], s94 offen offset:0 lds
    buffer_load_dwordx4 v26, s[60:63], s94 offen offset:1024 lds
    buffer_load_dwordx4 v27, s[60:63], s94 offen offset:2048 lds
    buffer_load_dwordx4 v28, s[60:63], s94 offen offset:3072 lds
L_nou10:
    s_lshl_b32 s14, s9, 2
    s_add_u32 s14, s14, 162832
    v_mov_b32 v3, s14
    v_mov_b32 v13, 1
    s_mov_b32 s95, s91
    s_mov_b32 s90, s96
    s_cmp_eq_u32 s9, 3
    s_cmov_b32 s90, 122880
    s_lshl_b32 s88, s9, 2
    s_waitcnt vmcnt(0)
    ds_write_b32 v3, v13
    s_mov_b32 s13, 0
L_aspin:
    ds_read_b32 v15, v3 offset:32
    s_waitcnt lgkmcnt(0)
    v_readfirstlane_b32 s14, v15
    s_add_u32 s13, s13, 1
    s_cmp_lg_u32 s14, 0
    s_cbranch_scc1 L_aspin_ok
    s_sleep 2
    s_cmp_lt_u32 s13, 200000
    s_cbranch_scc1 L_aspin
L_aspin_ok:
    v_and_b32 v14, 7, v0
    v_lshrrev_b32 v15, 3, v0
    v_lshl_add_u32 v14, v15, 5, v14
    v_lshlrev_b32 v14, 7, v14
    s_lshl4_add_u32 s15, s10, s9
    s_lshl_b32 s15, s15, 9
    s_add_u32 s15, s15, 0x70000
    s_movk_i32 s96, 0x0f0f
    s_cmp_lt_u32 s9, 3
    s_cmovk_i32 s96, 0x1f1f
    s_mov_b32 exec_lo, s96
    s_mov_b32 exec_hi, 0
    s_mov_b32 s13, 0
L_apoll:
    buffer_load_dword v15, v14, s[84:87], s15 offen offset:0 sc1
    s_add_u32 s13, s13, 1
    s_waitcnt vmcnt(0)
    v_cmp_ne_u32 vcc, s8, v15
    s_cbranch_vccz L_apoll_ok
    s_sleep 4
    s_cmp_lt_u32 s13, 200000
    s_cbranch_scc1 L_apoll
L_apoll_ok:
    s_mov_b64 exec, -1
    s_setprio 1
    v_lshlrev_b32 v0, 4, v0
    s_mul_i32 s92, s10, 311296
    s_mul_i32 s14, s9, 22528
    s_add_u32 s92, s92, s14
    s_lshr_b32 s44, s44, 4
    s_lshr_b32 s45, s45, 4
    s_add_u32 s93, s44, 0
    s_sub_u32 s94, s93, s45
    s_min_u32 s93, s93, s94
    s_add_u32 s93, s93, s92
    s_add_u32 s94, s93, 155648
    buffer_load_dwordx4 v[8:11], v0, s[72:75], s93 offen offset:0 sc1
    buffer_load_dwordx4 v[12:15], v0, s[72:75], s94 offen offset:0 sc1
    buffer_load_dwordx4 v[16:19], v0, s[72:75], s93 offen offset:1024 sc1
    buffer_load_dwordx4 v[20:23], v0, s[72:75], s94 offen offset:1024 sc1
    s_add_u32 s93, s44, 2048
    s_sub_u32 s94, s93, s45
    s_min_u32 s93, s93, s94
    s_add_u32 s93, s93, s92
    s_add_u32 s94, s93, 155648
    buffer_load_dwordx4 v[24:27], v0, s[72:75], s93 offen offset:0 sc1
    buffer_load_dwordx4 v[28:31], v0, s[72:75], s94 offen offset:0 sc1
    buffer_load_dwordx4 v[32:35], v0, s[72:75], s93 offen offset:1024 sc1
    buffer_load_dwordx4 v[36:39], v0, s[72:75], s94 offen offset:1024 sc1
    s_add_u32 s93, s44, 10240
    s_sub_u32 s94, s93, s45
    s_min_u32 s93, s93, s94
    s_add_u32 s93, s93, s92
    s_add_u32 s94, s93, 155648
    buffer_load_dwordx4 v[40:43], v0, s[72:75], s93 offen offset:0 sc1
    buffer_load_dwordx4 v[44:47], v0, s[72:75], s94 offen offset:0 sc1
    s_waitcnt vmcnt(8)
    v_mfma_f32_32x32x16_bf16 v[48:63], v[8:11], v[112:115], 0
    v_mfma_f32_32x32x16_bf16 v[64:79], v[8:11], v[116:119], 0
    v_mfma_f32_32x32x16_bf16 v[80:95], v[12:15], v[112:115], 0
    v_mfma_f32_32x32x16_bf16 v[96:111], v[12:15], v[116:119], 0
    buffer_load_dwordx4 v[8:11], v0, s[72:75], s93 offen offset:1024 sc1
    buffer_load_dwordx4 v[12:15], v0, s[72:75], s94 offen offset:1024 sc1
    s_add_u32 s93, s44, 12288
    s_sub_u32 s94, s93, s45
    s_min_u32 s93, s93, s94
    s_add_u32 s93, s93, s92
    s_add_u32 s94, s93, 155648
    buffer_load_dwordx4 v[112:115], v0, s[72:75], s93 offen offset:0 sc1
    buffer_load_dwordx4 v[116:119], v0, s[72:75], s94 offen offset:0 sc1
    s_waitcnt vmcnt(10)
    v_mfma_f32_32x32x16_bf16 v[48:63], v[16:19], v[120:123], v[48:63]
    v_mfma_f32_32x32x16_bf16 v[64:79], v[16:19], v[124:127], v[64:79]
    v_mfma_f32_32x32x16_bf16 v[80:95], v[20:23], v[120:123], v[80:95]
    v_mfma_f32_32x32x16_bf16 v[96:111], v[20:23], v[124:127], v[96:111]
    buffer_load_dwordx4 v[16:19], v0, s[72:75], s93 offen offset:1024 sc1
    buffer_load_dwordx4 v[20:23], v0, s[72:75], s94 offen offset:1024 sc1
    s_add_u32 s93, s44, 4096
    s_sub_u32 s94, s93, s45
    s_min_u32 s93, s93, s94
    s_add_u32 s93, s93, s92
    s_add_u32 s94, s93, 155648
    buffer_load_dwordx4 v[120:123], v0, s[72:75], s93 offen offset:0 sc1
    buffer_load_dwordx4 v[124:127], v0, s[72:75], s94 offen offset:0 sc1
    s_waitcnt vmcnt(12)
    v_mfma_f32_32x32x16_bf16 v[48:63], v[24:27], v[128:131], v[48:63]
    v_mfma_f32_32x32x16_bf16 v[64:79], v[24:27], v[132:135], v[64:79]
    v_mfma_f32_32x32x16_bf16 v[80:95], v[28:31], v[128:131], v[80:95]
    v_mfma_f32_32x32x16_bf16 v[96:111], v[28:31], v[132:135], v[96:111]
    buffer_load_dwordx4 v[24:27], v0, s[72:75], s93 offen offset:1024 sc1
    buffer_load_dwordx4 v[28:31], v0, s[72:75], s94 offen offset:1024 sc1
    s_waitcnt vmcnt(12)
    v_mfma_f32_32x32x16_bf16 v[48:63], v[32:35], v[136:139], v[48:63]
    v_mfma_f32_32x32x16_bf16 v[64:79], v[32:35], v[140:143], v[64:79]
    v_mfma_f32_32x32x16_bf16 v[80:95], v[36:39], v[136:139], v[80:95]
    v_mfma_f32_32x32x16_bf16 v[96:111], v[36:39], v[140:143], v[96:111]
    s_add_u32 s93, s44, 6144
    s_sub_u32 s94, s93, s45
    s_min_u32 s93, s93, s94
    s_add_u32 s93, s93, s92
    s_add_u32 s94, s93, 155648
    buffer_load_dwordx4 v[128:131], v0, s[72:75], s93 offen offset:0 sc1
    buffer_load_dwordx4 v[132:135], v0, s[72:75], s94 offen offset:0 sc1
    ds_write_b32 v3, v3 offset:48
    s_waitcnt vmcnt(12)
    v_mfma_f32_32x32x16_bf16 v[48:63], v[40:43], v[144:147], v[48:63]
    v_mfma_f32_32x32x16_bf16 v[64:79], v[40:43], v[148:151], v[64:79]
    v_mfma_f32_32x32x16_bf16 v[80:95], v[44:47], v[144:147], v[80:95]
    v_mfma_f32_32x32x16_bf16 v[96:111], v[44:47], v[148:151], v[96:111]
    buffer_load_dwordx4 v[32:35], v0, s[72:75], s93 offen offset:1024 sc1
    buffer_load_dwordx4 v[36:39], v0, s[72:75], s94 offen offset:1024 sc1
    s_waitcnt vmcnt(12)
    v_mfma_f32_32x32x16_bf16 v[48:63], v[8:11], v[152:155], v[48:63]
    v_mfma_f32_32x32x16_bf16 v[64:79], v[8:11], v[156:159], v[64:79]
    v_mfma_f32_32x32x16_bf16 v[80:95], v[12:15], v[152:155], v[80:95]
    v_mfma_f32_32x32x16_bf16 v[96:111], v[12:15], v[156:159], v[96:111]
    s_add_u32 s93, s44, 14336
    s_sub_u32 s94, s93, s45
    s_min_u32 s93, s93, s94
    s_add_u32 s93, s93, s92
    s_add_u32 s94, s93, 155648
    buffer_load_dwordx4 v[136:139], v0, s[72:75], s93 offen offset:0 sc1
    buffer_load_dwordx4 v[140:143], v0, s[72:75], s94 offen offset:0 sc1
    s_waitcnt vmcnt(12)
    v_mfma_f32_32x32x16_bf16 v[48:63], v[112:115], v[160:163], v[48:63]
    v_mfma_f32_32x32x16_bf16 v[64:79], v[112:115], v[164:167], v[64:79]
    v_mfma_f32_32x32x16_bf16 v[80:95], v[116:119], v[160:163], v[80:95]
    v_mfma_f32_32x32x16_bf16 v[96:111], v[116:119], v[164:167], v[96:111]
    buffer_load_dwordx4 v[40:43], v0, s[72:75], s93 offen offset:1024 sc1
    buffer_load_dwordx4 v[44:47], v0, s[72:75], s94 offen offset:1024 sc1
    s_waitcnt vmcnt(12)
    v_mfma_f32_32x32x16_bf16 v[48:63], v[16:19], v[168:171], v[48:63]
    v_mfma_f32_32x32x16_bf16 v[64:79], v[16:19], v[172:175], v[64:79]
    v_mfma_f32_32x32x16_bf16 v[80:95], v[20:23], v[168:171], v[80:95]
    v_mfma_f32_32x32x16_bf16 v[96:111], v[20:23], v[172:175], v[96:111]
    s_add_u32 s93, s44, 16384
    s_sub_u32 s94, s93, s45
    s_min_u32 s93, s93, s94
    s_add_u32 s93, s93, s92
    s_add_u32 s94, s93, 155648
    buffer_load_dwordx4 v[8:11], v0, s[72:75], s93 offen offset:0 sc1
    buffer_load_dwordx4 v[12:15], v0, s[72:75], s94 offen offset:0 sc1
    s_waitcnt vmcnt(12)
    v_mfma_f32_32x32x16_bf16 v[48:63], v[120:123], v[176:179], v[48:63]
    v_mfma_f32_32x32x16_bf16 v[64:79], v[120:123], v[180:183], v[64:79]
    v_mfma_f32_32x32x16_bf16 v[80:95], v[124:127], v[176:179], v[80:95]
    v_mfma_f32_32x32x16_bf16 v[96:111], v[124:127], v[180:183], v[96:111]
    buffer_load_dwordx4 v[112:115], v0, s[72:75], s93 offen offset:1024 sc1
    buffer_load_dwordx4 v[116:119], v0, s[72:75], s94 offen offset:1024 sc1
    s_waitcnt vmcnt(12)
    v_mfma_f32_32x32x16_bf16 v[48:63], v[24:27], v[184:187], v[48:63]
    v_mfma_f32_32x32x16_bf16 v[64:79], v[24:27], v[188:191], v[64:79]
    v_mfma_f32_32x32x16_bf16 v[80:95], v[28:31], v[184:187], v[80:95]
    v_mfma_f32_32x32x16_bf16 v[96:111], v[28:31], v[188:191], v[96:111]
    s_add_u32 s93, s44, 8192
    s_sub_u32 s94, s93, s45
    s_min_u32 s93, s93, s94
    s_add_u32 s93, s93, s92
    s_add_u32 s94, s93, 155648
    buffer_load_dwordx4 v[16:19], v0, s[72:75], s93 offen offset:0 sc1
    buffer_load_dwordx4 v[20:23], v0, s[72:75], s94 offen offset:0 sc1
    s_add_u32 s14, s95, 143360
    v_add_u32 v6, s14, v4
    v_add_u32 v7, s14, v5
    ds_read_b64_tr_b16 v[144:145], v6 offset:0
    ds_read_b64_tr_b16 v[146:147], v6 offset:1024
    ds_read_b64_tr_b16 v[148:149], v7 offset:0
    ds_read_b64_tr_b16 v[150:151], v7 offset:1024
    ds_read_b64_tr_b16 v[152:153], v6 offset:2048
    ds_read_b64_tr_b16 v[154:155], v6 offset:3072
    ds_read_b64_tr_b16 v[156:157], v7 offset:2048
    ds_read_b64_tr_b16 v[158:159], v7 offset:3072
    s_waitcnt vmcnt(12)
    v_mfma_f32_32x32x16_bf16 v[48:63], v[128:131], v[192:195], v[48:63]
    v_mfma_f32_32x32x16_bf16 v[64:79], v[128:131], v[196:199], v[64:79]
    v_mfma_f32_32x32x16_bf16 v[80:95], v[132:135], v[192:195], v[80:95]
    v_mfma_f32_32x32x16_bf16 v[96:111], v[132:135], v[196:199], v[96:111]
    buffer_load_dwordx4 v[120:123], v0, s[72:75], s93 offen offset:1024 sc1
    buffer_load_dwordx4 v[124:127], v0, s[72:75], s94 offen offset:1024 sc1
    s_waitcnt vmcnt(12)
    v_mfma_f32_32x32x16_bf16 v[48:63], v[32:35], v[200:203], v[48:63]
    v_mfma_f32_32x32x16_bf16 v[64:79], v[32:35], v[204:207], v[64:79]
    v_mfma_f32_32x32x16_bf16 v[80:95], v[36:39], v[200:203], v[80:95]
    v_mfma_f32_32x32x16_bf16 v[96:111], v[36:39], v[204:207], v[96:111]
    s_add_u32 s93, s44, 18432
    s_sub_u32 s94, s93, s45
    s_min_u32 s93, s93, s94
    s_add_u32 s93, s93, s92
    s_add_u32 s94, s93, 155648
    buffer_load_dwordx4 v[176:179], v0, s[72:75], s93 offen offset:0 sc1
    buffer_load_dwordx4 v[180:183], v0, s[72:75], s94 offen offset:0 sc1
    s_waitcnt lgkmcnt(4)
    s_add_u32 s14, s90, 32768
    v_add_u32 v6, s14, v4
    v_add_u32 v7, s14, v5
    ds_read_b64_tr_b16 v[160:161], v6 offset:0
    ds_read_b64_tr_b16 v[162:163], v6 offset:1024
    ds_read_b64_tr_b16 v[164:165], v7 offset:0
    ds_read_b64_tr_b16 v[166:167], v7 offset:1024
    ds_read_b64_tr_b16 v[168:169], v6 offset:2048
    ds_read_b64_tr_b16 v[170:171], v6 offset:3072
    ds_read_b64_tr_b16 v[172:173], v7 offset:2048
    ds_read_b64_tr_b16 v[174:175], v7 offset:3072
    s_waitcnt vmcnt(12)
    v_mfma_f32_32x32x16_bf16 v[48:63], v[136:139], v[208:211], v[48:63]
    v_mfma_f32_32x32x16_bf16 v[64:79], v[136:139], v[212:215], v[64:79]
    v_mfma_f32_32x32x16_bf16 v[80:95], v[140:143], v[208:211], v[80:95]
    v_mfma_f32_32x32x16_bf16 v[96:111], v[140:143], v[212:215], v[96:111]
    buffer_load_dwordx4 v[24:27], v0, s[72:75], s93 offen offset:1024 sc1
    buffer_load_dwordx4 v[28:31], v0, s[72:75], s94 offen offset:1024 sc1
    s_waitcnt vmcnt(12)
    v_mfma_f32_32x32x16_bf16 v[48:63], v[40:43], v[216:219], v[48:63]
    v_mfma_f32_32x32x16_bf16 v[64:79], v[40:43], v[220:223], v[64:79]
    v_mfma_f32_32x32x16_bf16 v[80:95], v[44:47], v[216:219], v[80:95]
    v_mfma_f32_32x32x16_bf16 v[96:111], v[44:47], v[220:223], v[96:111]
    s_cmp_eq_u32 s9, 3
    s_cselect_b32 s92, 0x40000000, s92
    s_add_u32 s93, s44, 20480
    s_sub_u32 s94, s93, s45
    s_min_u32 s93, s93, s94
    s_add_u32 s93, s93, s92
    s_add_u32 s94, s93, 155648
    buffer_load_dwordx4 v[184:187], v0, s[72:75], s93 offen offset:0 sc1
    buffer_load_dwordx4 v[188:191], v0, s[72:75], s94 offen offset:0 sc1
    s_waitcnt vmcnt(12)
    v_mfma_f32_32x32x16_bf16 v[48:63], v[8:11], v[224:227], v[48:63]
    v_mfma_f32_32x32x16_bf16 v[64:79], v[8:11], v[228:231], v[64:79]
    v_mfma_f32_32x32x16_bf16 v[80:95], v[12:15], v[224:227], v[80:95]
    v_mfma_f32_32x32x16_bf16 v[96:111], v[12:15], v[228:231], v[96:111]
    buffer_load_dwordx4 v[128:131], v0, s[72:75], s93 offen offset:1024 sc1
    buffer_load_dwordx4 v[132:135], v0, s[72:75], s94 offen offset:1024 sc1
    s_waitcnt vmcnt(12)
    v_mfma_f32_32x32x16_bf16 v[48:63], v[112:115], v[232:235], v[48:63]
    v_mfma_f32_32x32x16_bf16 v[64:79], v[112:115], v[236:239], v[64:79]
    v_mfma_f32_32x32x16_bf16 v[80:95], v[116:119], v[232:235], v[80:95]
    v_mfma_f32_32x32x16_bf16 v[96:111], v[116:119], v[236:239], v[96:111]
    s_waitcnt vmcnt(10)
    v_mfma_f32_32x32x16_bf16 v[48:63], v[16:19], v[240:243], v[48:63]
    v_mfma_f32_32x32x16_bf16 v[64:79], v[16:19], v[244:247], v[64:79]
    v_mfma_f32_32x32x16_bf16 v[80:95], v[20:23], v[240:243], v[80:95]
    v_mfma_f32_32x32x16_bf16 v[96:111], v[20:23], v[244:247], v[96:111]
    s_lshl_b32 s14, s10, 6
    s_lshr_b32 s15, s9, 1
    s_lshl_b32 s15, s15, 5
    s_add_u32 s14, s14, s15
    s_lshr_b32 s15, s3, 2
    s_lshl_b32 s15, s15, 3
    s_add_u32 s91, s14, s15
    s_lshl_b32 s14, s11, 6
    s_and_b32 s15, s9, 1
    s_lshl_b32 s15, s15, 5
    s_add_u32 s14, s14, s15
    v_add_lshl_u32 v4, v1, s14, 1
    v_lshl_add_u32 v5, v2, 4, s91
    v_lshl_add_u32 v5, v5, 10, v4
    global_load_ushort v216, v4, s[0:1]
    s_movk_i32 s14, 0x1000
    buffer_load_ushort v208, v5, s[48:51], 0 offen offset:0
    buffer_load_ushort v209, v5, s[48:51], 0 offen offset:1024
    buffer_load_ushort v210, v5, s[48:51], 0 offen offset:2048
    buffer_load_ushort v211, v5, s[48:51], 0 offen offset:3072
    buffer_load_ushort v212, v5, s[48:51], s14 offen offset:0
    buffer_load_ushort v213, v5, s[48:51], s14 offen offset:1024
    buffer_load_ushort v214, v5, s[48:51], s14 offen offset:2048
    buffer_load_ushort v215, v5, s[48:51], s14 offen offset:3072
    s_waitcnt vmcnt(17)
    v_mfma_f32_32x32x16_bf16 v[48:63], v[120:123], v[248:251], v[48:63]
    v_mfma_f32_32x32x16_bf16 v[64:79], v[120:123], v[252:255], v[64:79]
    v_mfma_f32_32x32x16_bf16 v[80:95], v[124:127], v[248:251], v[80:95]
    v_mfma_f32_32x32x16_bf16 v[96:111], v[124:127], v[252:255], v[96:111]
    s_mov_b32 s13, 0
L_pspin:
    ds_read_b32 v6, v3 offset:16
    s_waitcnt lgkmcnt(0)
    v_readfirstlane_b32 s14, v6
    s_add_u32 s13, s13, 1
    s_cmp_lg_u32 s14, 0
    s_cbranch_scc1 L_pspin_ok
    s_sleep 2
    s_cmp_lt_u32 s13, 200000
    s_cbranch_scc1 L_pspin
L_pspin_ok:
    s_add_u32 s14, s89, 73728
    v_add_u32 v7, s14, v0
    s_waitcnt vmcnt(9)
    v_mfma_f32_32x32x16_bf16 v[48:63], v[176:179], v[144:147], v[48:63]
    v_mfma_f32_32x32x16_bf16 v[48:63], v[24:27], v[152:155], v[48:63]
    v_mfma_f32_32x32x16_bf16 v[48:63], v[184:187], v[160:163], v[48:63]
    v_mfma_f32_32x32x16_bf16 v[48:63], v[128:131], v[168:171], v[48:63]
    v_mfma_f32_32x32x16_bf16 v[64:79], v[176:179], v[148:151], v[64:79]
    v_mfma_f32_32x32x16_bf16 v[64:79], v[24:27], v[156:159], v[64:79]
s_nop 9
    ds_write_b128 v7, v[48:51] offset:0
    ds_write_b128 v7, v[60:63] offset:3072
    v_mfma_f32_32x32x16_bf16 v[64:79], v[184:187], v[164:167], v[64:79]
    ds_write_b128 v7, v[52:55] offset:1024
    v_mfma_f32_32x32x16_bf16 v[64:79], v[128:131], v[172:175], v[64:79]
    ds_write_b128 v7, v[56:59] offset:2048
    v_mfma_f32_32x32x16_bf16 v[80:95], v[180:183], v[144:147], v[80:95]
    v_mfma_f32_32x32x16_bf16 v[80:95], v[28:31], v[152:155], v[80:95]
s_nop 8
    ds_write_b128 v7, v[64:67] offset:4096
    ds_write_b128 v7, v[76:79] offset:7168
    v_mfma_f32_32x32x16_bf16 v[80:95], v[188:191], v[160:163], v[80:95]
    ds_write_b128 v7, v[68:71] offset:5120
    v_mfma_f32_32x32x16_bf16 v[80:95], v[132:135], v[168:171], v[80:95]
    ds_write_b128 v7, v[72:75] offset:6144
    v_mfma_f32_32x32x16_bf16 v[96:111], v[180:183], v[148:151], v[96:111]
    v_mfma_f32_32x32x16_bf16 v[96:111], v[28:31], v[156:159], v[96:111]
s_nop 8
    ds_write_b128 v7, v[80:83] offset:36864
    ds_write_b128 v7, v[92:95] offset:39936
    v_mfma_f32_32x32x16_bf16 v[96:111], v[188:191], v[164:167], v[96:111]
    ds_write_b128 v7, v[84:87] offset:37888
    v_mfma_f32_32x32x16_bf16 v[96:111], v[132:135], v[172:175], v[96:111]
    ds_write_b128 v7, v[88:91] offset:38912
s_nop 10
    ds_write_b128 v7, v[96:99] offset:40960
    ds_write_b128 v7, v[108:111] offset:44032
    ds_write_b128 v7, v[100:103] offset:41984
    ds_write_b128 v7, v[104:107] offset:43008
    v_mov_b32 v12, v5
    v_mov_b32 v13, v0
L_final:
    s_lshr_b32 s15, s3, 2
    s_lshl_b32 s15, s15, 11
    s_and_b32 s14, s9, 1
    s_lshl_b32 s14, s14, 12
    s_add_u32 s14, s14, s15
    s_lshr_b32 s15, s9, 1
    s_mul_i32 s15, s15, 36864
    s_add_u32 s14, s14, s15
    v_add_u32 v16, s14, v13
    v_add_u32 v18, 73728, v16
    s_and_b32 s14, s91, 63
    s_lshl_b32 s14, s14, 2
    s_add_u32 s14, s14, 160256
    v_lshl_add_u32 v22, v2, 6, s14
    ds_read_b128 v[24:27], v22
    ds_read_b128 v[28:31], v22 offset:16
    ds_read_b128 v[32:35], v22 offset:256
    ds_read_b128 v[36:39], v22 offset:272
    s_waitcnt lgkmcnt(0)
    s_barrier
    ds_read_b128 v[144:147], v18 offset:0
    ds_read_b128 v[148:151], v18 offset:1024
    ds_read_b128 v[152:155], v18 offset:8192
    ds_read_b128 v[156:159], v18 offset:9216
    ds_read_b128 v[160:163], v18 offset:16384
    ds_read_b128 v[164:167], v18 offset:17408
    ds_read_b128 v[168:171], v18 offset:24576
    ds_read_b128 v[172:175], v18 offset:25600
    ds_read_b128 v[176:179], v16 offset:0
    ds_read_b128 v[180:183], v16 offset:1024
    ds_read_b128 v[184:187], v16 offset:8192
    ds_read_b128 v[188:191], v16 offset:9216
    ds_read_b128 v[192:195], v16 offset:16384
    ds_read_b128 v[196:199], v16 offset:17408
    ds_read_b128 v[200:203], v16 offset:24576
    ds_read_b128 v[204:207], v16 offset:25600
    s_waitcnt vmcnt(0)
    s_lshl_b32 s14, s11, 5
    s_add_u32 s14, s14, s10
    s_lshl_b32 s15, s3, 8
    s_add_u32 s14, s14, s15
    s_cmp_lg_u32 s14, 31
    s_cbranch_scc1 L_noep
    v_mov_b32 v14, 0
    v_mov_b32 v15, s8
    s_mov_b64 exec, 1
    global_store_dword v14, v15, s[46:47]
    s_mov_b64 exec, -1
L_noep:
    v_lshlrev_b32 v208, 16, v208
    v_lshlrev_b32 v209, 16, v209
    v_lshlrev_b32 v210, 16, v210
    v_lshlrev_b32 v211, 16, v211
    v_lshlrev_b32 v212, 16, v212
    v_lshlrev_b32 v213, 16, v213
    v_lshlrev_b32 v214, 16, v214
    v_lshlrev_b32 v215, 16, v215
    v_lshlrev_b32 v216, 16, v216
    v_pk_add_f32 v[32:33], v[32:33], v[208:209]
    v_pk_mul_f32 v[32:33], v[32:33], v[24:25]
    v_pk_add_f32 v[34:35], v[34:35], v[210:211]
    v_pk_mul_f32 v[34:35], v[34:35], v[26:27]
    v_pk_add_f32 v[36:37], v[36:37], v[212:213]
    v_pk_mul_f32 v[36:37], v[36:37], v[28:29]
    v_pk_add_f32 v[38:39], v[38:39], v[214:215]
    v_pk_mul_f32 v[38:39], v[38:39], v[30:31]
    v_lshlrev_b32 v12, 1, v12
    s_waitcnt lgkmcnt(8)
    v_pk_add_f32 v[144:145], v[144:145], v[152:153]
    v_pk_add_f32 v[160:161], v[160:161], v[168:169]
    v_pk_add_f32 v[146:147], v[146:147], v[154:155]
    v_pk_add_f32 v[162:163], v[162:163], v[170:171]
    v_pk_add_f32 v[148:149], v[148:149], v[156:157]
    v_pk_add_f32 v[164:165], v[164:165], v[172:173]
    v_pk_add_f32 v[150:151], v[150:151], v[158:159]
    v_pk_add_f32 v[166:167], v[166:167], v[174:175]
    v_pk_add_f32 v[144:145], v[144:145], v[160:161]
    v_pk_add_f32 v[146:147], v[146:147], v[162:163]
    v_pk_add_f32 v[148:149], v[148:149], v[164:165]
    v_pk_add_f32 v[150:151], v[150:151], v[166:167]
    v_mul_f32 v152, 0xbfb8aa3b, v144
    v_mul_f32 v153, 0xbfb8aa3b, v145
    v_mul_f32 v154, 0xbfb8aa3b, v146
    v_mul_f32 v155, 0xbfb8aa3b, v147
    v_mul_f32 v156, 0xbfb8aa3b, v148
    v_mul_f32 v157, 0xbfb8aa3b, v149
    v_mul_f32 v158, 0xbfb8aa3b, v150
    v_mul_f32 v159, 0xbfb8aa3b, v151
    v_exp_f32 v152, v152
    v_exp_f32 v153, v153
    v_exp_f32 v154, v154
    v_exp_f32 v155, v155
    v_exp_f32 v156, v156
    v_exp_f32 v157, v157
    v_exp_f32 v158, v158
    v_exp_f32 v159, v159
    v_add_f32 v152, 1.0, v152
    v_add_f32 v153, 1.0, v153
    v_add_f32 v154, 1.0, v154
    v_add_f32 v155, 1.0, v155
    v_add_f32 v156, 1.0, v156
    v_add_f32 v157, 1.0, v157
    v_add_f32 v158, 1.0, v158
    v_add_f32 v159, 1.0, v159
    v_rcp_f32 v152, v152
    v_rcp_f32 v153, v153
    v_rcp_f32 v154, v154
    v_rcp_f32 v155, v155
    v_rcp_f32 v156, v156
    v_rcp_f32 v157, v157
    v_rcp_f32 v158, v158
    v_rcp_f32 v159, v159
    s_waitcnt lgkmcnt(0)
    v_pk_add_f32 v[176:177], v[176:177], v[184:185]
    v_pk_add_f32 v[192:193], v[192:193], v[200:201]
    v_pk_add_f32 v[178:179], v[178:179], v[186:187]
    v_pk_add_f32 v[194:195], v[194:195], v[202:203]
    v_pk_add_f32 v[180:181], v[180:181], v[188:189]
    v_pk_add_f32 v[196:197], v[196:197], v[204:205]
    v_pk_add_f32 v[182:183], v[182:183], v[190:191]
    v_pk_add_f32 v[198:199], v[198:199], v[206:207]
    v_pk_add_f32 v[176:177], v[176:177], v[192:193]
    v_pk_mul_f32 v[144:145], v[144:145], v[152:153]
    v_pk_add_f32 v[178:179], v[178:179], v[194:195]
    v_pk_mul_f32 v[146:147], v[146:147], v[154:155]
    v_pk_add_f32 v[180:181], v[180:181], v[196:197]
    v_pk_mul_f32 v[148:149], v[148:149], v[156:157]
    v_pk_add_f32 v[182:183], v[182:183], v[198:199]
    v_pk_mul_f32 v[150:151], v[150:151], v[158:159]
    v_fmac_f32 v176, v32, v216
    v_fmac_f32 v177, v33, v216
    v_fmac_f32 v178, v34, v216
    v_fmac_f32 v179, v35, v216
    v_fmac_f32 v180, v36, v216
    v_fmac_f32 v181, v37, v216
    v_fmac_f32 v182, v38, v216
    v_fmac_f32 v183, v39, v216
    s_movk_i32 s92, 0x1000
    s_movk_i32 s93, 0x2000
    s_movk_i32 s94, 0x3000
    v_fmac_f32 v208, v176, v144
    buffer_store_dword v208, v12, s[76:79], 0 offen offset:0 sc1
    v_fmac_f32 v209, v177, v145
    buffer_store_dword v209, v12, s[76:79], 0 offen offset:2048 sc1
    v_fmac_f32 v210, v178, v146
    buffer_store_dword v210, v12, s[76:79], s92 offen offset:0 sc1
    v_fmac_f32 v211, v179, v147
    buffer_store_dword v211, v12, s[76:79], s92 offen offset:2048 sc1
    v_fmac_f32 v212, v180, v148
    buffer_store_dword v212, v12, s[76:79], s93 offen offset:0 sc1
    v_fmac_f32 v213, v181, v149
    buffer_store_dword v213, v12, s[76:79], s93 offen offset:2048 sc1
    v_fmac_f32 v214, v182, v150
    buffer_store_dword v214, v12, s[76:79], s94 offen offset:0 sc1
    v_fmac_f32 v215, v183, v151
    buffer_store_dword v215, v12, s[76:79], s94 offen offset:2048 sc1
L_end:
    s_endpgm
.section .rodata,"a"
.p2align 6
.amdhsa_kernel recurrent_scan__ssm_conv_s5__dense_activation_mish__prompt_kernel
  .amdhsa_next_free_vgpr 256
  .amdhsa_next_free_sgpr 102
  .amdhsa_accum_offset 256
  .amdhsa_group_segment_fixed_size 0
  .amdhsa_kernarg_size 128
  .amdhsa_user_sgpr_count 2
  .amdhsa_user_sgpr_kernarg_segment_ptr 1
  .amdhsa_system_sgpr_workgroup_id_x 1
.end_amdhsa_kernel
```
